```python
import torch

def _softmax(x, axis=-1):
    return torch.softmax(x, dim=axis)
def _gelu(x):
    return torch.nn.functional.gelu(x, approximate="tanh")
def _silu(x):
    return torch.nn.functional.silu(x)
def _sigmoid(x):
    return torch.sigmoid(x)
def _layernorm(x, axis=-1, eps=1e-5):
    m = x.mean(dim=axis, keepdim=True)
    v = x.var(dim=axis, keepdim=True, unbiased=False)
    return (x - m) / torch.sqrt(v + eps)
def _scatter_add(tgt, idx, src, axis=0):
    return tgt.clone().index_add_(axis, idx, src)
def _segment_sum(src, seg, n):
    out = torch.zeros((n,) + src.shape[1:], dtype=src.dtype)
    return out.index_add_(0, seg, src)
def _pad(x, pw):
    flat = tuple(v for pair in reversed(pw) for v in pair)
    return torch.nn.functional.pad(x, flat)

kernel_name = 'concat_heads__gqa_block_cached__compressed_kv_cla__decode'

def setup_inputs():

    _w = (lambda a: (lambda t: t.to(torch.bfloat16) if t.is_floating_point() else t)(torch.as_tensor(a)))
    def _A_setup():
        B, Sq, D = 2, 1, 512
        Hq, Hkv, Sk, Dh = 32, 8, 8192, 128
        assert Hq % Hkv == 0, (Hq, Hkv)
        return {
            "x": _w((lambda *s: torch.randn(*s, dtype=torch.bfloat16) * 1.6)(B, Sq, D)),
            "k_cache": _w((lambda *s: torch.randn(*s, dtype=torch.bfloat16) * 1.6)(B, Hkv, Sk, Dh)),
            "v_cache": _w((lambda *s: torch.randn(*s, dtype=torch.bfloat16) * 0.05)(B, Hkv, Sk, Dh)),
            "wq": _w((lambda *s: torch.randn(*s, dtype=torch.bfloat16) * 1.6)(D, Hq * Dh) * (D ** -0.5)),
            "wo": _w((lambda *s: torch.randn(*s, dtype=torch.bfloat16) * 0.05)(Hq * Dh, D) * ((Hq * Dh) ** -0.5)),
        }
    _A_in = _A_setup()

    def _B_setup():
        B, H, Sq, Sk, D, M = 2, 32, 1, 8192, 128, 512
        Dc = 4 * D
        return {
            "x": _w((lambda *s: torch.randn(*s, dtype=torch.bfloat16) * 3.2)(B, Sq, M)),
            "c_kv": _w((lambda *s: torch.randn(*s, dtype=torch.bfloat16) * 0.1)(B, Sk, Dc)),
            "w_q": _w((lambda *s: torch.randn(*s, dtype=torch.bfloat16) * 6.4)(M, H, D) * (M ** -0.5)),
            "w_uk": _w((lambda *s: torch.randn(*s, dtype=torch.bfloat16) * 6.4)(Dc, H, D) * (Dc ** -0.5)),
            "w_uv": _w((lambda *s: torch.randn(*s, dtype=torch.bfloat16) * 0.1)(Dc, H, D) * (Dc ** -0.5)),
            "w_o": _w((lambda *s: torch.randn(*s, dtype=torch.bfloat16) * 0.1)(H, D, M) * ((H * D) ** -0.5)),
        }
    _B_in = _B_setup()

    return {
        "A_x": _A_in["x"],
        "A_k_cache": _A_in["k_cache"],
        "A_v_cache": _A_in["v_cache"],
        "A_wq": _A_in["wq"],
        "A_wo": _A_in["wo"],
        "B_x": _B_in["x"],
        "B_c_kv": _B_in["c_kv"],
        "B_w_q": _B_in["w_q"],
        "B_w_uk": _B_in["w_uk"],
        "B_w_uv": _B_in["w_uv"],
        "B_w_o": _B_in["w_o"],
    }

def reference(A_x, A_k_cache, A_v_cache, A_wq, A_wo, B_x, B_c_kv, B_w_q, B_w_uk, B_w_uv, B_w_o):
    def _A_ref(x, k_cache, v_cache, wq, wo):
        B, Sq, D = x.shape
        Hq, Dh = 32, 128
        Hkv = k_cache.shape[1]
        rep = Hq // Hkv
        q = (lambda x, *d: x.permute(*d))((x @ wq).reshape(B, Sq, Hq, Dh), 0, 2, 1, 3)
        k = (lambda x, n, axis: torch.repeat_interleave(x, n, dim=axis))(k_cache, rep, axis=1)
        v = (lambda x, n, axis: torch.repeat_interleave(x, n, dim=axis))(v_cache, rep, axis=1)
        scores = torch.einsum("bhqd,bhkd->bhqk", q, k) * (Dh ** -0.5)
        p = _softmax(scores, axis=-1)
        o = torch.einsum("bhqk,bhkd->bhqd", p, v)
        return (lambda x, *d: x.permute(*d))(o, 0, 2, 1, 3).reshape(B, Sq, Hq * Dh) @ wo

    def _B_ref(x, c_kv, w_q, w_uk, w_uv, w_o):
        B, Sq, M = x.shape[0], x.shape[1], x.shape[2]
        Sk = c_kv.shape[1]
        H, D = w_q.shape[1], w_q.shape[2]
        q = torch.einsum("bqm,mhd->bhqd", x, w_q)
        k = torch.einsum("bkc,chd->bhkd", c_kv, w_uk)
        v = torch.einsum("bkc,chd->bhkd", c_kv, w_uv)
        scores = torch.einsum("bhqd,bhkd->bhqk", q, k) * (D ** -0.5)
        off = Sk - Sq
        qi = torch.arange(Sq)[:, None]
        kj = torch.arange(Sk)[None, :]
        cmask = kj <= (qi + off)
        scores = torch.where(cmask[None, None], scores, -1e9)
        p = _softmax(scores, axis=-1)
        ctx = torch.einsum("bhqk,bhkd->bhqd", p, v)
        return torch.einsum("bhqd,hdm->bqm", ctx, w_o)

    a = _A_ref(A_x, A_k_cache, A_v_cache, A_wq, A_wo)
    b = _B_ref(B_x, B_c_kv, B_w_q, B_w_uk, B_w_uv, B_w_o)
    return torch.concatenate([a, b], axis=-1)
```

```asm
; @launch grid=(256,1,1) block=(1024,1,1) lds=163840
.amdgcn_target "amdgcn-amd-amdhsa--gfx950"
.text
.globl concat_heads__gqa_block_cached__compressed_kv_cla__decode_kernel
.p2align 8
.type concat_heads__gqa_block_cached__compressed_kv_cla__decode_kernel,@function
concat_heads__gqa_block_cached__compressed_kv_cla__decode_kernel:
    s_cmp_ge_u32 s2, 256
    s_cbranch_scc1 L_exit
    s_load_dwordx16 s[4:19], s[0:1], 0
    s_load_dwordx8 s[20:27], s[0:1], 64
    s_load_dwordx4 s[28:31], s[0:1], 96
    v_lshrrev_b32 v1, 6, v0
    v_and_b32 v0, 63, v0
    v_readfirstlane_b32 s3, v1
    s_mov_b32 s58, 0x05040100
    s_mov_b32 s59, 0x07060302
    s_mov_b32 s71, 0x3e0293ee
    s_cmp_lt_u32 s2, 64
    s_cbranch_scc1 L_t
    s_cmp_lt_u32 s2, 128
    s_cbranch_scc1 L_b
    s_branch L_aatt
L_exit:
    s_endpgm
L_aatt:
    s_and_b32 s61, s2, 7
    s_bfe_u32 s68, s2, 0x40003
    v_bfe_u32 v3, v0, 2, 2
    v_lshlrev_b32 v2, 8, v3
    v_lshrrev_b32 v4, 4, v0
    v_lshl_add_u32 v2, v4, 6, v2
    v_and_b32 v5, 3, v0
    v_lshl_add_u32 v2, v5, 4, v2
    v_lshlrev_b32 v1, 4, v0
    s_lshr_b32 s64, s68, 3
    s_lshl_b32 s60, s64, 3
    s_add_u32 s60, s60, s61
    s_lshl_b32 s60, s60, 3
    s_and_b32 s65, s68, 7
    s_add_u32 s60, s60, s65
    s_lshl_b32 s60, s60, 18
    s_mul_i32 s65, s3, 2048
    s_add_u32 s60, s60, s65
    v_lshlrev_b32 v13, 14, v4
    v_and_b32 v14, 15, v0
    v_lshl_add_u32 v13, v14, 4, v13
    v_and_b32 v14, 1, v0
    v_lshlrev_b32 v14, 10, v14
    v_lshl_add_u32 v14, v4, 2, v14
    s_lshr_b32 s66, s68, 2
    s_lshl_b32 s66, s66, 4
    s_add_u32 s66, s66, s3
    s_lshl_b32 s69, s66, 4
    s_lshl_b32 s66, s66, 16
    s_lshl_b32 s67, s61, 2
    s_and_b32 s70, s68, 3
    s_add_u32 s67, s67, s70
    s_lshl_b32 s67, s67, 8
    s_add_u32 s66, s66, s67
    s_add_u32 s67, s66, 8192
    v_mov_b32 v12, 512
    v_mov_b32 v8, 0
    v_mov_b32 v9, 0
    v_mov_b32 v10, 0
    v_mov_b32 v11, 0
    ds_write_b128 v12, v[8:11]
    s_waitcnt lgkmcnt(0)
    s_load_dword s56, s[30:31], 0
    s_mov_b32 s44, s18
    s_mov_b32 s45, s19
    s_mov_b32 s46, 0x400000
    s_mov_b32 s47, 0x20000
    s_mov_b32 s48, s14
    s_mov_b32 s49, s15
    s_mov_b32 s50, 0x800
    s_mov_b32 s51, 0x20000
    buffer_load_dword v40, v14, s[48:51], s69 offen
    buffer_load_dwordx4 v[32:35], v13, s[44:47], s66 offen nt
    buffer_load_dwordx4 v[36:39], v13, s[44:47], s67 offen nt
    s_mov_b32 s36, s10
    s_mov_b32 s37, s11
    s_mov_b32 s38, 0x400000
    s_mov_b32 s39, 0x20000
    s_mov_b32 s40, s4
    s_mov_b32 s41, s5
    s_mov_b32 s42, 0x800
    s_mov_b32 s43, 0x20000
    s_mov_b32 s32, s30
    s_mov_b32 s33, s31
    s_mov_b32 s34, 0x10000000
    s_mov_b32 s35, 0x20000
    s_barrier
    s_waitcnt vmcnt(0)
    buffer_load_dword v24, v14, s[40:43], s69 offen
    buffer_load_dwordx4 v[16:19], v13, s[36:39], s66 offen nt
    buffer_load_dwordx4 v[20:23], v13, s[36:39], s67 offen nt
    s_mov_b32 s36, s6
    s_mov_b32 s37, s7
    s_mov_b32 s38, 0x2000000
    s_mov_b32 s39, 0x20000
    s_mov_b32 s40, s8
    s_mov_b32 s41, s9
    s_mov_b32 s42, 0x2000000
    s_mov_b32 s43, 0x20000
    s_waitcnt lgkmcnt(0)
    s_mul_i32 s56, s56, 1664525
    s_add_u32 s56, s56, 1013904223
    s_mov_b32 s28, 0x03020104
    s_and_b32 s29, s56, 0xff
    v_mov_b32 v41, 0
    v_mov_b32 v42, 0
    v_mov_b32 v43, 0
    v_mov_b32 v45, 0
    v_mov_b32 v46, 0
    v_mov_b32 v47, 0
    v_mov_b32 v49, 0
    v_mov_b32 v50, 0
    v_mov_b32 v51, 0
    v_and_b32 v52, 15, v0
    v_lshlrev_b32 v53, 3, v52
    s_lshl_b32 s66, s3, 10
    s_add_u32 s66, s66, 45056
    v_add_u32 v53, s66, v53
    s_waitcnt vmcnt(3)
    v_perm_b32 v44, v36, v32, s58
    s_nop 1
    v_mfma_f32_16x16x32_bf16 v[96:99], v[40:43], v[44:47], 0
    v_perm_b32 v48, v36, v32, s59
    s_nop 1
    v_mfma_f32_16x16x32_bf16 v[100:103], v[40:43], v[48:51], 0
    v_perm_b32 v44, v37, v33, s58
    s_nop 1
    v_mfma_f32_16x16x32_bf16 v[104:107], v[40:43], v[44:47], 0
    v_perm_b32 v48, v37, v33, s59
    s_nop 1
    v_mfma_f32_16x16x32_bf16 v[108:111], v[40:43], v[48:51], 0
    v_perm_b32 v44, v38, v34, s58
    s_nop 1
    v_mfma_f32_16x16x32_bf16 v[112:115], v[40:43], v[44:47], 0
    v_perm_b32 v48, v38, v34, s59
    s_nop 1
    v_mfma_f32_16x16x32_bf16 v[116:119], v[40:43], v[48:51], 0
    v_perm_b32 v44, v39, v35, s58
    s_nop 1
    v_mfma_f32_16x16x32_bf16 v[120:123], v[40:43], v[44:47], 0
    v_perm_b32 v48, v39, v35, s59
    s_nop 1
    v_mfma_f32_16x16x32_bf16 v[124:127], v[40:43], v[48:51], 0
    s_mov_b64 exec, 0xffff
    ds_write_b64 v53, v[96:97] offset:0
    ds_write_b64 v53, v[100:101] offset:128
    ds_write_b64 v53, v[104:105] offset:256
    ds_write_b64 v53, v[108:109] offset:384
    ds_write_b64 v53, v[112:113] offset:512
    ds_write_b64 v53, v[116:117] offset:640
    ds_write_b64 v53, v[120:121] offset:768
    ds_write_b64 v53, v[124:125] offset:896
    s_mov_b64 exec, -1
    v_mov_b32 v12, 516
    v_mov_b32 v13, 1
    s_mov_b64 exec, 1
    ds_add_u32 v12, v13
    s_mov_b64 exec, -1
    s_lshr_b32 s66, s3, 1
    s_cmp_lg_u32 s66, 0
    s_cbranch_scc1 L_nred_1
    s_and_b32 s70, s3, 1
    v_lshrrev_b32 v54, 4, v0
    v_lshlrev_b32 v53, 8, v54
    v_lshl_add_u32 v53, v52, 3, v53
    s_lshl_b32 s66, s70, 2
    s_add_u32 s66, s66, 45056
    v_add_u32 v53, s66, v53
    v_add_u32 v55, 128, v53
    v_lshlrev_b32 v56, 5, v52
    v_lshl_add_u32 v56, v54, 3, v56
    v_mov_b32 v57, s56
    s_lshl_b32 s66, s61, 2
    s_and_b32 s67, s68, 3
    s_add_u32 s66, s66, s67
    s_lshl_b32 s66, s66, 12
    s_lshl_b32 s67, s70, 11
    s_add_u32 s66, s66, s67
    s_lshr_b32 s67, s68, 2
    s_lshl_b32 s67, s67, 9
    s_add_u32 s66, s66, s67
    s_add_u32 s66, s66, 524288
    s_mov_b32 s57, 800000
    v_mov_b32 v12, 516
L_lsl_4:
    ds_read_b32 v13, v12
    s_waitcnt lgkmcnt(0)
    v_readfirstlane_b32 s62, v13
    s_cmp_ge_u32 s62, 16
    s_cbranch_scc1 L_lok_3
    s_sleep 1
    s_sub_u32 s57, s57, 1
    s_cmp_lg_u32 s57, 0
    s_cbranch_scc1 L_lsl_4
L_lok_3:
    ds_read2st64_b32 v[96:97], v53 offset0:0 offset1:4
    ds_read2st64_b32 v[112:113], v55 offset0:0 offset1:4
    ds_read2st64_b32 v[98:99], v53 offset0:8 offset1:12
    ds_read2st64_b32 v[114:115], v55 offset0:8 offset1:12
    ds_read2st64_b32 v[100:101], v53 offset0:16 offset1:20
    ds_read2st64_b32 v[116:117], v55 offset0:16 offset1:20
    ds_read2st64_b32 v[102:103], v53 offset0:24 offset1:28
    ds_read2st64_b32 v[118:119], v55 offset0:24 offset1:28
    ds_read2st64_b32 v[104:105], v53 offset0:32 offset1:36
    ds_read2st64_b32 v[120:121], v55 offset0:32 offset1:36
    ds_read2st64_b32 v[106:107], v53 offset0:40 offset1:44
    ds_read2st64_b32 v[122:123], v55 offset0:40 offset1:44
    ds_read2st64_b32 v[108:109], v53 offset0:48 offset1:52
    ds_read2st64_b32 v[124:125], v55 offset0:48 offset1:52
    ds_read2st64_b32 v[110:111], v53 offset0:56 offset1:60
    ds_read2st64_b32 v[126:127], v55 offset0:56 offset1:60
    s_waitcnt lgkmcnt(0)
    v_pk_add_f32 v[96:97], v[96:97], v[104:105]
    v_pk_add_f32 v[98:99], v[98:99], v[106:107]
    v_pk_add_f32 v[100:101], v[100:101], v[108:109]
    v_pk_add_f32 v[102:103], v[102:103], v[110:111]
    v_pk_add_f32 v[96:97], v[96:97], v[100:101]
    v_pk_add_f32 v[98:99], v[98:99], v[102:103]
    v_pk_add_f32 v[96:97], v[96:97], v[98:99]
    v_pk_add_f32 v[112:113], v[112:113], v[120:121]
    v_pk_add_f32 v[114:115], v[114:115], v[122:123]
    v_pk_add_f32 v[116:117], v[116:117], v[124:125]
    v_pk_add_f32 v[118:119], v[118:119], v[126:127]
    v_pk_add_f32 v[112:113], v[112:113], v[116:117]
    v_pk_add_f32 v[114:115], v[114:115], v[118:119]
    v_pk_add_f32 v[112:113], v[112:113], v[114:115]
    v_add_f32 v58, v96, v97
    v_add_f32 v59, v112, v113
    v_perm_b32 v58, v57, v58, s28
    v_perm_b32 v59, v57, v59, s28
    buffer_store_dwordx2 v[58:59], v56, s[32:35], s66 offen
    s_add_u32 s53, s66, 1048576
    buffer_store_dwordx2 v[58:59], v56, s[32:35], s53 offen sc1
L_nred_1:
    s_add_u32 s65, s60, 0
    buffer_load_dwordx4 v[64:67], v2, s[36:39], s65 offen nt
    s_lshl_b32 s66, s61, 2
    s_lshr_b32 s67, s3, 2
    s_add_u32 s66, s66, s67
    s_lshl_b32 s66, s66, 12
    s_lshl_b32 s64, s64, 11
    s_add_u32 s64, s64, s66
    s_and_b32 s66, s3, 3
    s_lshl_b32 s69, s66, 9
    s_add_u32 s64, s64, s69
    s_add_u32 s64, s64, 393216
    v_lshlrev_b32 v5, 3, v0
    s_mov_b32 s44, 0x11111111
    s_mov_b32 s45, 0x11111111
    s_mov_b32 s46, 0x22222222
    s_mov_b32 s47, 0x22222222
    s_mov_b32 s48, 0x44444444
    s_mov_b32 s49, 0x44444444
    s_mov_b32 s50, 0x88888888
    s_mov_b32 s51, 0x88888888
    s_lshl_b32 s66, s66, 11
    s_lshl_b32 s67, s67, 9
    s_add_u32 s66, s66, s67
    s_add_u32 s66, s66, 1024
    v_lshlrev_b32 v6, 3, v0
    v_add_u32 v6, s66, v6
    v_lshlrev_b32 v7, 1, v2
    s_waitcnt vmcnt(0)
    s_add_u32 s65, s60, 1024
    buffer_load_dwordx4 v[68:71], v2, s[36:39], s65 offen nt
    v_mov_b32 v25, 0
    v_mov_b32 v26, 0
    v_mov_b32 v27, 0
    v_and_b32 v52, 15, v0
    v_lshlrev_b32 v53, 3, v52
    s_lshl_b32 s66, s3, 10
    s_add_u32 s66, s66, 61440
    v_add_u32 v53, s66, v53
    v_perm_b32 v44, v20, v16, s58
    s_nop 1
    v_mfma_f32_16x16x32_bf16 v[96:99], v[24:27], v[44:47], 0
    v_perm_b32 v48, v20, v16, s59
    s_nop 1
    v_mfma_f32_16x16x32_bf16 v[100:103], v[24:27], v[48:51], 0
    v_perm_b32 v44, v21, v17, s58
    s_nop 1
    v_mfma_f32_16x16x32_bf16 v[104:107], v[24:27], v[44:47], 0
    v_perm_b32 v48, v21, v17, s59
    s_nop 1
    v_mfma_f32_16x16x32_bf16 v[108:111], v[24:27], v[48:51], 0
    v_perm_b32 v44, v22, v18, s58
    s_nop 1
    v_mfma_f32_16x16x32_bf16 v[112:115], v[24:27], v[44:47], 0
    v_perm_b32 v48, v22, v18, s59
    s_nop 1
    v_mfma_f32_16x16x32_bf16 v[116:119], v[24:27], v[48:51], 0
    v_perm_b32 v44, v23, v19, s58
    s_nop 1
    v_mfma_f32_16x16x32_bf16 v[120:123], v[24:27], v[44:47], 0
    v_perm_b32 v48, v23, v19, s59
    s_nop 1
    v_mfma_f32_16x16x32_bf16 v[124:127], v[24:27], v[48:51], 0
    s_mov_b64 exec, 0xffff
    ds_write_b64 v53, v[96:97] offset:0
    ds_write_b64 v53, v[100:101] offset:128
    ds_write_b64 v53, v[104:105] offset:256
    ds_write_b64 v53, v[108:109] offset:384
    ds_write_b64 v53, v[112:113] offset:512
    ds_write_b64 v53, v[116:117] offset:640
    ds_write_b64 v53, v[120:121] offset:768
    ds_write_b64 v53, v[124:125] offset:896
    s_mov_b64 exec, -1
    v_mov_b32 v12, 524
    v_mov_b32 v13, 1
    s_mov_b64 exec, 1
    ds_add_u32 v12, v13
    s_mov_b64 exec, -1
    s_waitcnt vmcnt(0)
    s_add_u32 s65, s60, 32768
    buffer_load_dwordx4 v[72:75], v2, s[36:39], s65 offen nt
    s_lshr_b32 s66, s3, 1
    s_cmp_lg_u32 s66, 1
    s_cbranch_scc1 L_nred_5
    s_and_b32 s70, s3, 1
    v_lshrrev_b32 v54, 4, v0
    v_lshlrev_b32 v53, 8, v54
    v_lshl_add_u32 v53, v52, 3, v53
    s_lshl_b32 s66, s70, 2
    s_add_u32 s66, s66, 61440
    v_add_u32 v53, s66, v53
    v_add_u32 v55, 128, v53
    v_lshlrev_b32 v56, 5, v52
    v_lshl_add_u32 v56, v54, 3, v56
    v_mov_b32 v57, s56
    s_lshl_b32 s66, s61, 2
    s_and_b32 s67, s68, 3
    s_add_u32 s66, s66, s67
    s_lshl_b32 s66, s66, 12
    s_lshl_b32 s67, s70, 11
    s_add_u32 s66, s66, s67
    s_lshr_b32 s67, s68, 2
    s_lshl_b32 s67, s67, 9
    s_add_u32 s66, s66, s67
    s_add_u32 s66, s66, 393216
    s_mov_b32 s57, 800000
    v_mov_b32 v12, 524
L_lsl_8:
    ds_read_b32 v13, v12
    s_waitcnt lgkmcnt(0)
    v_readfirstlane_b32 s62, v13
    s_cmp_ge_u32 s62, 16
    s_cbranch_scc1 L_lok_7
    s_sleep 1
    s_sub_u32 s57, s57, 1
    s_cmp_lg_u32 s57, 0
    s_cbranch_scc1 L_lsl_8
L_lok_7:
    ds_read2st64_b32 v[96:97], v53 offset0:0 offset1:4
    ds_read2st64_b32 v[112:113], v55 offset0:0 offset1:4
    ds_read2st64_b32 v[98:99], v53 offset0:8 offset1:12
    ds_read2st64_b32 v[114:115], v55 offset0:8 offset1:12
    ds_read2st64_b32 v[100:101], v53 offset0:16 offset1:20
    ds_read2st64_b32 v[116:117], v55 offset0:16 offset1:20
    ds_read2st64_b32 v[102:103], v53 offset0:24 offset1:28
    ds_read2st64_b32 v[118:119], v55 offset0:24 offset1:28
    ds_read2st64_b32 v[104:105], v53 offset0:32 offset1:36
    ds_read2st64_b32 v[120:121], v55 offset0:32 offset1:36
    ds_read2st64_b32 v[106:107], v53 offset0:40 offset1:44
    ds_read2st64_b32 v[122:123], v55 offset0:40 offset1:44
    ds_read2st64_b32 v[108:109], v53 offset0:48 offset1:52
    ds_read2st64_b32 v[124:125], v55 offset0:48 offset1:52
    ds_read2st64_b32 v[110:111], v53 offset0:56 offset1:60
    ds_read2st64_b32 v[126:127], v55 offset0:56 offset1:60
    s_waitcnt lgkmcnt(0)
    v_pk_add_f32 v[96:97], v[96:97], v[104:105]
    v_pk_add_f32 v[98:99], v[98:99], v[106:107]
    v_pk_add_f32 v[100:101], v[100:101], v[108:109]
    v_pk_add_f32 v[102:103], v[102:103], v[110:111]
    v_pk_add_f32 v[96:97], v[96:97], v[100:101]
    v_pk_add_f32 v[98:99], v[98:99], v[102:103]
    v_pk_add_f32 v[96:97], v[96:97], v[98:99]
    v_pk_add_f32 v[112:113], v[112:113], v[120:121]
    v_pk_add_f32 v[114:115], v[114:115], v[122:123]
    v_pk_add_f32 v[116:117], v[116:117], v[124:125]
    v_pk_add_f32 v[118:119], v[118:119], v[126:127]
    v_pk_add_f32 v[112:113], v[112:113], v[116:117]
    v_pk_add_f32 v[114:115], v[114:115], v[118:119]
    v_pk_add_f32 v[112:113], v[112:113], v[114:115]
    v_add_f32 v58, v96, v97
    v_add_f32 v59, v112, v113
    v_perm_b32 v58, v57, v58, s28
    v_perm_b32 v59, v57, v59, s28
    buffer_store_dwordx2 v[58:59], v56, s[32:35], s66 offen sc1
L_nred_5:
    s_waitcnt vmcnt(2)
    s_add_u32 s65, s60, 33792
    buffer_load_dwordx4 v[76:79], v2, s[36:39], s65 offen nt
    s_waitcnt vmcnt(2)
    s_add_u32 s65, s60, 65536
    buffer_load_dwordx4 v[80:83], v2, s[36:39], s65 offen nt
    s_waitcnt vmcnt(2)
    s_add_u32 s65, s60, 66560
    buffer_load_dwordx4 v[84:87], v2, s[36:39], s65 offen nt
    s_waitcnt vmcnt(2)
    s_add_u32 s65, s60, 98304
    buffer_load_dwordx4 v[88:91], v2, s[36:39], s65 offen nt
    s_waitcnt vmcnt(2)
    s_add_u32 s65, s60, 99328
    buffer_load_dwordx4 v[92:95], v2, s[36:39], s65 offen nt
    s_waitcnt vmcnt(2)
    s_add_u32 s65, s60, 131072
    buffer_load_dwordx4 v[96:99], v2, s[36:39], s65 offen nt
    buffer_load_dwordx2 v[8:9], v5, s[32:35], s64 offen sc1
    s_waitcnt vmcnt(2)
    s_add_u32 s65, s60, 132096
    buffer_load_dwordx4 v[100:103], v2, s[36:39], s65 offen nt
    s_waitcnt vmcnt(2)
    s_add_u32 s65, s60, 163840
    buffer_load_dwordx4 v[104:107], v2, s[36:39], s65 offen nt
    s_waitcnt vmcnt(2)
    s_add_u32 s65, s60, 164864
    buffer_load_dwordx4 v[108:111], v2, s[36:39], s65 offen nt
    s_mov_b32 s57, 200000
    s_waitcnt vmcnt(3)
    s_branch L_chk_11
L_poll_9:
    buffer_load_dwordx2 v[8:9], v5, s[32:35], s64 offen sc1
    s_waitcnt vmcnt(0)
L_chk_11:
    v_xor_b32 v8, s29, v8
    v_xor_b32 v9, s29, v9
    v_or_b32 v10, v8, v9
    v_and_b32 v10, 0xff, v10
    v_cmp_ne_u32 vcc, 0, v10
    s_cmp_eq_u64 vcc, 0
    s_cbranch_scc1 L_ok_10
    s_sleep 8
    s_sub_u32 s57, s57, 1
    s_cmp_lg_u32 s57, 0
    s_cbranch_scc1 L_poll_9
L_ok_10:
    ds_write_b64 v6, v[8:9]
    v_mov_b32 v12, 512
    v_mov_b32 v13, 1
    s_mov_b64 exec, 1
    ds_add_u32 v12, v13
    s_mov_b64 exec, -1
    s_waitcnt vmcnt(2)
    s_add_u32 s65, s60, 196608
    buffer_load_dwordx4 v[112:115], v2, s[36:39], s65 offen nt
    s_waitcnt vmcnt(2)
    s_add_u32 s65, s60, 197632
    buffer_load_dwordx4 v[116:119], v2, s[36:39], s65 offen nt
    s_waitcnt vmcnt(2)
    s_add_u32 s65, s60, 229376
    buffer_load_dwordx4 v[120:123], v2, s[36:39], s65 offen nt
    s_mov_b32 s57, 800000
    v_mov_b32 v12, 512
L_lw_12:
    ds_read_b32 v13, v12
    ds_read_b128 v[32:35], v7 offset:1024
    ds_read_b128 v[36:39], v7 offset:1040
    ds_read_b128 v[40:43], v7 offset:3072
    ds_read_b128 v[44:47], v7 offset:3088
    ds_read_b128 v[48:51], v7 offset:5120
    ds_read_b128 v[52:55], v7 offset:5136
    ds_read_b128 v[56:59], v7 offset:7168
    ds_read_b128 v[60:63], v7 offset:7184
    s_waitcnt lgkmcnt(8)
    v_readfirstlane_b32 s62, v13
    s_cmp_ge_u32 s62, 16
    s_cbranch_scc1 L_lok_13
L_lsl_14:
    ds_read_b32 v13, v12
    s_waitcnt lgkmcnt(0)
    v_readfirstlane_b32 s62, v13
    s_cmp_ge_u32 s62, 16
    s_cbranch_scc1 L_lw_12
    s_sleep 1
    s_sub_u32 s57, s57, 1
    s_cmp_lg_u32 s57, 0
    s_cbranch_scc1 L_lsl_14
L_lok_13:
    s_waitcnt lgkmcnt(0)
    v_pk_add_f32 v[32:33], v[32:33], v[48:49]
    v_pk_add_f32 v[34:35], v[34:35], v[50:51]
    v_pk_add_f32 v[36:37], v[36:37], v[52:53]
    v_pk_add_f32 v[38:39], v[38:39], v[54:55]
    v_pk_add_f32 v[40:41], v[40:41], v[56:57]
    v_pk_add_f32 v[42:43], v[42:43], v[58:59]
    v_pk_add_f32 v[44:45], v[44:45], v[60:61]
    v_pk_add_f32 v[46:47], v[46:47], v[62:63]
    v_pk_add_f32 v[32:33], v[32:33], v[40:41]
    v_pk_add_f32 v[34:35], v[34:35], v[42:43]
    v_pk_add_f32 v[36:37], v[36:37], v[44:45]
    v_pk_add_f32 v[38:39], v[38:39], v[46:47]
    v_cvt_pk_bf16_f32 v8, v32, v33
    v_cvt_pk_bf16_f32 v9, v34, v35
    v_cvt_pk_bf16_f32 v10, v36, v37
    v_cvt_pk_bf16_f32 v11, v38, v39
    v_lshlrev_b32 v6, 6, v3
    s_lshl_b32 s64, s3, 2
    v_add_u32 v7, s64, v6
    s_waitcnt vmcnt(2)
    s_add_u32 s65, s60, 230400
    buffer_load_dwordx4 v[124:127], v2, s[36:39], s65 offen nt
    v_mfma_f32_16x16x32_bf16 v[64:67], v[64:67], v[8:11], 0
    v_mfma_f32_16x16x32_bf16 v[68:71], v[68:71], v[8:11], 0
    v_mfma_f32_16x16x32_bf16 v[72:75], v[72:75], v[8:11], 0
    v_mfma_f32_16x16x32_bf16 v[76:79], v[76:79], v[8:11], 0
    v_mfma_f32_16x16x32_bf16 v[80:83], v[80:83], v[8:11], 0
    v_mfma_f32_16x16x32_bf16 v[84:87], v[84:87], v[8:11], 0
    v_mfma_f32_16x16x32_bf16 v[88:91], v[88:91], v[8:11], 0
    v_mfma_f32_16x16x32_bf16 v[92:95], v[92:95], v[8:11], 0
    s_nop 0
    v_mov_b32_dpp v16, v64 quad_perm:[0,0,0,0] row_mask:0xf bank_mask:0xf
    v_mov_b32_dpp v17, v68 quad_perm:[0,0,0,0] row_mask:0xf bank_mask:0xf
    v_mov_b32_dpp v18, v72 quad_perm:[0,0,0,0] row_mask:0xf bank_mask:0xf
    v_mov_b32_dpp v19, v76 quad_perm:[0,0,0,0] row_mask:0xf bank_mask:0xf
    v_add_f32_dpp v16, v65, v16 quad_perm:[1,1,1,1] row_mask:0xf bank_mask:0xf
    v_add_f32_dpp v17, v69, v17 quad_perm:[1,1,1,1] row_mask:0xf bank_mask:0xf
    v_add_f32_dpp v18, v73, v18 quad_perm:[1,1,1,1] row_mask:0xf bank_mask:0xf
    v_add_f32_dpp v19, v77, v19 quad_perm:[1,1,1,1] row_mask:0xf bank_mask:0xf
    v_add_f32_dpp v16, v66, v16 quad_perm:[2,2,2,2] row_mask:0xf bank_mask:0xf
    v_add_f32_dpp v17, v70, v17 quad_perm:[2,2,2,2] row_mask:0xf bank_mask:0xf
    v_add_f32_dpp v18, v74, v18 quad_perm:[2,2,2,2] row_mask:0xf bank_mask:0xf
    v_add_f32_dpp v19, v78, v19 quad_perm:[2,2,2,2] row_mask:0xf bank_mask:0xf
    v_add_f32_dpp v16, v67, v16 quad_perm:[3,3,3,3] row_mask:0xf bank_mask:0xf
    v_add_f32_dpp v17, v71, v17 quad_perm:[3,3,3,3] row_mask:0xf bank_mask:0xf
    v_add_f32_dpp v18, v75, v18 quad_perm:[3,3,3,3] row_mask:0xf bank_mask:0xf
    v_add_f32_dpp v19, v79, v19 quad_perm:[3,3,3,3] row_mask:0xf bank_mask:0xf
    v_mov_b32_dpp v20, v80 quad_perm:[0,0,0,0] row_mask:0xf bank_mask:0xf
    v_mov_b32_dpp v21, v84 quad_perm:[0,0,0,0] row_mask:0xf bank_mask:0xf
    v_mov_b32_dpp v22, v88 quad_perm:[0,0,0,0] row_mask:0xf bank_mask:0xf
    v_mov_b32_dpp v23, v92 quad_perm:[0,0,0,0] row_mask:0xf bank_mask:0xf
    v_add_f32_dpp v20, v81, v20 quad_perm:[1,1,1,1] row_mask:0xf bank_mask:0xf
    v_add_f32_dpp v21, v85, v21 quad_perm:[1,1,1,1] row_mask:0xf bank_mask:0xf
    v_add_f32_dpp v22, v89, v22 quad_perm:[1,1,1,1] row_mask:0xf bank_mask:0xf
    v_add_f32_dpp v23, v93, v23 quad_perm:[1,1,1,1] row_mask:0xf bank_mask:0xf
    v_add_f32_dpp v20, v82, v20 quad_perm:[2,2,2,2] row_mask:0xf bank_mask:0xf
    v_add_f32_dpp v21, v86, v21 quad_perm:[2,2,2,2] row_mask:0xf bank_mask:0xf
    v_add_f32_dpp v22, v90, v22 quad_perm:[2,2,2,2] row_mask:0xf bank_mask:0xf
    v_add_f32_dpp v23, v94, v23 quad_perm:[2,2,2,2] row_mask:0xf bank_mask:0xf
    v_add_f32_dpp v20, v83, v20 quad_perm:[3,3,3,3] row_mask:0xf bank_mask:0xf
    v_add_f32_dpp v21, v87, v21 quad_perm:[3,3,3,3] row_mask:0xf bank_mask:0xf
    v_add_f32_dpp v22, v91, v22 quad_perm:[3,3,3,3] row_mask:0xf bank_mask:0xf
    v_add_f32_dpp v23, v95, v23 quad_perm:[3,3,3,3] row_mask:0xf bank_mask:0xf
    s_waitcnt vmcnt(2)
    s_add_u32 s65, s60, 0
    buffer_load_dwordx4 v[32:35], v1, s[40:43], s65 offen nt
    v_mfma_f32_16x16x32_bf16 v[96:99], v[96:99], v[8:11], 0
    v_mfma_f32_16x16x32_bf16 v[100:103], v[100:103], v[8:11], 0
    v_mfma_f32_16x16x32_bf16 v[104:107], v[104:107], v[8:11], 0
    v_mfma_f32_16x16x32_bf16 v[108:111], v[108:111], v[8:11], 0
    s_nop 4
    v_mov_b32_dpp v24, v96 quad_perm:[0,0,0,0] row_mask:0xf bank_mask:0xf
    v_mov_b32_dpp v25, v100 quad_perm:[0,0,0,0] row_mask:0xf bank_mask:0xf
    v_mov_b32_dpp v26, v104 quad_perm:[0,0,0,0] row_mask:0xf bank_mask:0xf
    v_mov_b32_dpp v27, v108 quad_perm:[0,0,0,0] row_mask:0xf bank_mask:0xf
    v_add_f32_dpp v24, v97, v24 quad_perm:[1,1,1,1] row_mask:0xf bank_mask:0xf
    v_add_f32_dpp v25, v101, v25 quad_perm:[1,1,1,1] row_mask:0xf bank_mask:0xf
    v_add_f32_dpp v26, v105, v26 quad_perm:[1,1,1,1] row_mask:0xf bank_mask:0xf
    v_add_f32_dpp v27, v109, v27 quad_perm:[1,1,1,1] row_mask:0xf bank_mask:0xf
    v_add_f32_dpp v24, v98, v24 quad_perm:[2,2,2,2] row_mask:0xf bank_mask:0xf
    v_add_f32_dpp v25, v102, v25 quad_perm:[2,2,2,2] row_mask:0xf bank_mask:0xf
    v_add_f32_dpp v26, v106, v26 quad_perm:[2,2,2,2] row_mask:0xf bank_mask:0xf
    v_add_f32_dpp v27, v110, v27 quad_perm:[2,2,2,2] row_mask:0xf bank_mask:0xf
    v_add_f32_dpp v24, v99, v24 quad_perm:[3,3,3,3] row_mask:0xf bank_mask:0xf
    v_add_f32_dpp v25, v103, v25 quad_perm:[3,3,3,3] row_mask:0xf bank_mask:0xf
    v_add_f32_dpp v26, v107, v26 quad_perm:[3,3,3,3] row_mask:0xf bank_mask:0xf
    v_add_f32_dpp v27, v111, v27 quad_perm:[3,3,3,3] row_mask:0xf bank_mask:0xf
    s_waitcnt vmcnt(2)
    s_add_u32 s65, s60, 1024
    buffer_load_dwordx4 v[36:39], v1, s[40:43], s65 offen nt
    s_waitcnt vmcnt(2)
    s_add_u32 s65, s60, 32768
    buffer_load_dwordx4 v[40:43], v1, s[40:43], s65 offen nt
    v_mfma_f32_16x16x32_bf16 v[112:115], v[112:115], v[8:11], 0
    v_mfma_f32_16x16x32_bf16 v[116:119], v[116:119], v[8:11], 0
    v_mfma_f32_16x16x32_bf16 v[120:123], v[120:123], v[8:11], 0
    v_mfma_f32_16x16x32_bf16 v[124:127], v[124:127], v[8:11], 0
    s_nop 4
    v_mov_b32_dpp v28, v112 quad_perm:[0,0,0,0] row_mask:0xf bank_mask:0xf
    v_mov_b32_dpp v29, v116 quad_perm:[0,0,0,0] row_mask:0xf bank_mask:0xf
    v_mov_b32_dpp v30, v120 quad_perm:[0,0,0,0] row_mask:0xf bank_mask:0xf
    v_mov_b32_dpp v31, v124 quad_perm:[0,0,0,0] row_mask:0xf bank_mask:0xf
    v_add_f32_dpp v28, v113, v28 quad_perm:[1,1,1,1] row_mask:0xf bank_mask:0xf
    v_add_f32_dpp v29, v117, v29 quad_perm:[1,1,1,1] row_mask:0xf bank_mask:0xf
    v_add_f32_dpp v30, v121, v30 quad_perm:[1,1,1,1] row_mask:0xf bank_mask:0xf
    v_add_f32_dpp v31, v125, v31 quad_perm:[1,1,1,1] row_mask:0xf bank_mask:0xf
    v_add_f32_dpp v28, v114, v28 quad_perm:[2,2,2,2] row_mask:0xf bank_mask:0xf
    v_add_f32_dpp v29, v118, v29 quad_perm:[2,2,2,2] row_mask:0xf bank_mask:0xf
    v_add_f32_dpp v30, v122, v30 quad_perm:[2,2,2,2] row_mask:0xf bank_mask:0xf
    v_add_f32_dpp v31, v126, v31 quad_perm:[2,2,2,2] row_mask:0xf bank_mask:0xf
    v_add_f32_dpp v28, v115, v28 quad_perm:[3,3,3,3] row_mask:0xf bank_mask:0xf
    v_add_f32_dpp v29, v119, v29 quad_perm:[3,3,3,3] row_mask:0xf bank_mask:0xf
    v_add_f32_dpp v30, v123, v30 quad_perm:[3,3,3,3] row_mask:0xf bank_mask:0xf
    v_add_f32_dpp v31, v127, v31 quad_perm:[3,3,3,3] row_mask:0xf bank_mask:0xf
    v_max3_f32 v8, v16, v17, v18
    v_max3_f32 v8, v8, v19, v20
    v_max3_f32 v8, v8, v21, v22
    v_max3_f32 v8, v8, v23, v24
    v_max3_f32 v8, v8, v25, v26
    v_max3_f32 v8, v8, v27, v28
    v_max3_f32 v8, v8, v29, v30
    v_max_f32 v8, v8, v31
    v_mov_b32 v9, v8
    s_nop 1
    v_permlane32_swap_b32 v8, v9
    v_max_f32 v8, v8, v9
    v_mov_b32 v9, v8
    s_nop 1
    v_permlane16_swap_b32 v8, v9
    v_max_f32 v8, v8, v9
    v_mul_f32 v4, s71, v8
    ds_write_b32 v7, v4 offset:0
    s_waitcnt vmcnt(2)
    s_add_u32 s65, s60, 33792
    buffer_load_dwordx4 v[44:47], v1, s[40:43], s65 offen nt
    v_fma_f32 v16, v16, s71, -v4
    v_fma_f32 v17, v17, s71, -v4
    v_fma_f32 v18, v18, s71, -v4
    v_fma_f32 v19, v19, s71, -v4
    v_fma_f32 v20, v20, s71, -v4
    v_fma_f32 v21, v21, s71, -v4
    v_fma_f32 v22, v22, s71, -v4
    v_fma_f32 v23, v23, s71, -v4
    v_exp_f32 v16, v16
    v_exp_f32 v17, v17
    v_exp_f32 v18, v18
    v_exp_f32 v19, v19
    v_exp_f32 v20, v20
    v_exp_f32 v21, v21
    v_exp_f32 v22, v22
    v_exp_f32 v23, v23
    v_cvt_pk_bf16_f32 v8, v16, v17
    v_cvt_pk_bf16_f32 v9, v18, v19
    v_cvt_pk_bf16_f32 v10, v20, v21
    v_cvt_pk_bf16_f32 v11, v22, v23
    s_waitcnt vmcnt(2)
    s_add_u32 s65, s60, 65536
    buffer_load_dwordx4 v[48:51], v1, s[40:43], s65 offen nt
    v_fma_f32 v24, v24, s71, -v4
    v_fma_f32 v25, v25, s71, -v4
    v_fma_f32 v26, v26, s71, -v4
    v_fma_f32 v27, v27, s71, -v4
    v_fma_f32 v28, v28, s71, -v4
    v_fma_f32 v29, v29, s71, -v4
    v_fma_f32 v30, v30, s71, -v4
    v_fma_f32 v31, v31, s71, -v4
    v_exp_f32 v24, v24
    v_exp_f32 v25, v25
    v_exp_f32 v26, v26
    v_exp_f32 v27, v27
    v_exp_f32 v28, v28
    v_exp_f32 v29, v29
    v_exp_f32 v30, v30
    v_exp_f32 v31, v31
    v_cvt_pk_bf16_f32 v12, v24, v25
    v_cvt_pk_bf16_f32 v13, v26, v27
    v_cvt_pk_bf16_f32 v14, v28, v29
    v_cvt_pk_bf16_f32 v15, v30, v31
    s_waitcnt vmcnt(2)
    s_add_u32 s65, s60, 66560
    buffer_load_dwordx4 v[52:55], v1, s[40:43], s65 offen nt
    v_pk_add_f32 v[16:17], v[16:17], v[24:25]
    v_pk_add_f32 v[18:19], v[18:19], v[26:27]
    v_pk_add_f32 v[20:21], v[20:21], v[28:29]
    v_pk_add_f32 v[22:23], v[22:23], v[30:31]
    v_pk_add_f32 v[16:17], v[16:17], v[20:21]
    v_pk_add_f32 v[18:19], v[18:19], v[22:23]
    v_pk_add_f32 v[16:17], v[16:17], v[18:19]
    v_add_f32 v16, v16, v17
    v_mov_b32 v17, v16
    s_nop 1
    v_permlane32_swap_b32 v16, v17
    v_add_f32 v16, v16, v17
    v_mov_b32 v17, v16
    s_nop 1
    v_permlane16_swap_b32 v16, v17
    v_add_f32 v16, v16, v17
    ds_write_b32 v7, v16 offset:256
    v_mov_b32 v18, 520
    v_mov_b32 v19, 1
    s_mov_b64 exec, 1
    ds_add_u32 v18, v19
    s_mov_b64 exec, -1
    s_waitcnt vmcnt(2)
    s_add_u32 s65, s60, 98304
    buffer_load_dwordx4 v[56:59], v1, s[40:43], s65 offen nt
    v_cndmask_b32 v96, 0, v8, s[44:45]
    v_cndmask_b32 v97, 0, v9, s[44:45]
    v_cndmask_b32 v98, 0, v10, s[44:45]
    v_cndmask_b32 v99, 0, v11, s[44:45]
    v_cndmask_b32 v100, 0, v8, s[46:47]
    v_cndmask_b32 v101, 0, v9, s[46:47]
    v_cndmask_b32 v102, 0, v10, s[46:47]
    v_cndmask_b32 v103, 0, v11, s[46:47]
    v_cndmask_b32 v104, 0, v8, s[48:49]
    v_cndmask_b32 v105, 0, v9, s[48:49]
    v_cndmask_b32 v106, 0, v10, s[48:49]
    v_cndmask_b32 v107, 0, v11, s[48:49]
    v_cndmask_b32 v108, 0, v8, s[50:51]
    v_cndmask_b32 v109, 0, v9, s[50:51]
    v_cndmask_b32 v110, 0, v10, s[50:51]
    v_cndmask_b32 v111, 0, v11, s[50:51]
    v_cndmask_b32 v112, 0, v12, s[44:45]
    v_cndmask_b32 v113, 0, v13, s[44:45]
    v_cndmask_b32 v114, 0, v14, s[44:45]
    v_cndmask_b32 v115, 0, v15, s[44:45]
    v_cndmask_b32 v116, 0, v12, s[46:47]
    v_cndmask_b32 v117, 0, v13, s[46:47]
    v_cndmask_b32 v118, 0, v14, s[46:47]
    v_cndmask_b32 v119, 0, v15, s[46:47]
    v_cndmask_b32 v120, 0, v12, s[48:49]
    v_cndmask_b32 v121, 0, v13, s[48:49]
    v_cndmask_b32 v122, 0, v14, s[48:49]
    v_cndmask_b32 v123, 0, v15, s[48:49]
    v_cndmask_b32 v124, 0, v12, s[50:51]
    v_cndmask_b32 v125, 0, v13, s[50:51]
    v_cndmask_b32 v126, 0, v14, s[50:51]
    v_cndmask_b32 v127, 0, v15, s[50:51]
    s_waitcnt vmcnt(2)
    s_add_u32 s65, s60, 99328
    buffer_load_dwordx4 v[60:63], v1, s[40:43], s65 offen nt
    s_waitcnt vmcnt(2)
    s_add_u32 s65, s60, 131072
    buffer_load_dwordx4 v[64:67], v1, s[40:43], s65 offen nt
    s_cmp_lg_u32 s3, 0
    s_cbranch_scc1 L_skipml_15
    v_lshlrev_b32 v5, 2, v0
    s_mov_b32 s57, 800000
    v_mov_b32 v12, 520
L_lw_16:
    ds_read_b32 v13, v12
    ds_read_b32 v16, v5 offset:0
    ds_read_b32 v17, v5 offset:256
    s_waitcnt lgkmcnt(2)
    v_readfirstlane_b32 s62, v13
    s_cmp_ge_u32 s62, 16
    s_cbranch_scc1 L_lok_17
L_lsl_18:
    ds_read_b32 v13, v12
    s_waitcnt lgkmcnt(0)
    v_readfirstlane_b32 s62, v13
    s_cmp_ge_u32 s62, 16
    s_cbranch_scc1 L_lw_16
    s_sleep 1
    s_sub_u32 s57, s57, 1
    s_cmp_lg_u32 s57, 0
    s_cbranch_scc1 L_lsl_18
L_lok_17:
    s_lshl_b32 s64, s61, 10
    s_lshl_b32 s66, s68, 4
    s_add_u32 s64, s64, s66
    s_add_u32 s64, s64, 262144
    v_mov_b32 v21, s56
    v_mov_b32 v23, s56
    s_waitcnt lgkmcnt(0)
    v_max_f32_dpp v20, v16, v16 quad_perm:[1,0,3,2] row_mask:0xf bank_mask:0xf
    s_nop 1
    v_max_f32_dpp v20, v20, v20 quad_perm:[2,3,0,1] row_mask:0xf bank_mask:0xf
    s_nop 1
    v_max_f32_dpp v20, v20, v20 row_half_mirror row_mask:0xf bank_mask:0xf
    s_nop 1
    v_max_f32_dpp v20, v20, v20 row_mirror row_mask:0xf bank_mask:0xf
    v_sub_f32 v16, v16, v20
    v_exp_f32 v16, v16
    s_nop 0
    v_mul_f32 v22, v16, v17
    ds_write_b32 v5, v16 offset:768
    s_nop 0
    v_add_f32_dpp v22, v22, v22 quad_perm:[1,0,3,2] row_mask:0xf bank_mask:0xf
    s_nop 1
    v_add_f32_dpp v22, v22, v22 quad_perm:[2,3,0,1] row_mask:0xf bank_mask:0xf
    s_nop 1
    v_add_f32_dpp v22, v22, v22 row_half_mirror row_mask:0xf bank_mask:0xf
    s_nop 1
    v_add_f32_dpp v22, v22, v22 row_mirror row_mask:0xf bank_mask:0xf
    s_mov_b32 exec_lo, 0x00010001
    s_mov_b32 exec_hi, 0x00010001
    buffer_store_dwordx4 v[20:23], v1, s[32:35], s64 offen sc1
    s_mov_b64 exec, -1
    s_nop 1
L_skipml_15:
    v_lshlrev_b32 v5, 5, v0
    s_lshl_b32 s64, s3, 11
    s_add_u32 s64, s64, 10240
    v_add_u32 v5, s64, v5
    v_lshlrev_b32 v6, 3, v0
    s_lshl_b32 s64, s3, 9
    s_add_u32 s64, s64, 10240
    v_add_u32 v7, s64, v6
    s_lshl_b32 s64, s3, 6
    v_mov_b32 v4, s64
    s_lshl_b32 s64, s61, 2
    s_add_u32 s64, s64, s3
    s_lshl_b32 s64, s64, 13
    s_lshl_b32 s66, s68, 9
    s_add_u32 s64, s64, s66
    s_add_u32 s64, s64, 1048576
    s_waitcnt vmcnt(2)
    s_add_u32 s65, s60, 132096
    buffer_load_dwordx4 v[68:71], v1, s[40:43], s65 offen nt
    s_waitcnt vmcnt(2)
    s_add_u32 s65, s60, 163840
    buffer_load_dwordx4 v[72:75], v1, s[40:43], s65 offen nt
    v_perm_b32 v16, v36, v32, s58
    v_perm_b32 v17, v44, v40, s58
    v_perm_b32 v18, v52, v48, s58
    v_perm_b32 v19, v60, v56, s58
    s_nop 1
    v_mfma_f32_16x16x32_bf16 v[8:11], v[96:99], v[16:19], 0
    v_perm_b32 v20, v36, v32, s59
    v_perm_b32 v21, v44, v40, s59
    v_perm_b32 v22, v52, v48, s59
    v_perm_b32 v23, v60, v56, s59
    s_nop 1
    v_mfma_f32_16x16x32_bf16 v[8:11], v[100:103], v[20:23], v[8:11]
    v_perm_b32 v24, v37, v33, s58
    v_perm_b32 v25, v45, v41, s58
    v_perm_b32 v26, v53, v49, s58
    v_perm_b32 v27, v61, v57, s58
    s_nop 1
    v_mfma_f32_16x16x32_bf16 v[8:11], v[104:107], v[24:27], v[8:11]
    v_perm_b32 v28, v37, v33, s59
    v_perm_b32 v29, v45, v41, s59
    v_perm_b32 v30, v53, v49, s59
    v_perm_b32 v31, v61, v57, s59
    s_nop 1
    v_mfma_f32_16x16x32_bf16 v[8:11], v[108:111], v[28:31], v[8:11]
    s_waitcnt vmcnt(2)
    s_add_u32 s65, s60, 164864
    buffer_load_dwordx4 v[76:79], v1, s[40:43], s65 offen nt
    v_perm_b32 v16, v38, v34, s58
    v_perm_b32 v17, v46, v42, s58
    v_perm_b32 v18, v54, v50, s58
    v_perm_b32 v19, v62, v58, s58
    s_nop 1
    v_mfma_f32_16x16x32_bf16 v[12:15], v[96:99], v[16:19], 0
    v_perm_b32 v20, v38, v34, s59
    v_perm_b32 v21, v46, v42, s59
    v_perm_b32 v22, v54, v50, s59
    v_perm_b32 v23, v62, v58, s59
    s_nop 1
    v_mfma_f32_16x16x32_bf16 v[12:15], v[100:103], v[20:23], v[12:15]
    v_perm_b32 v24, v39, v35, s58
    v_perm_b32 v25, v47, v43, s58
    v_perm_b32 v26, v55, v51, s58
    v_perm_b32 v27, v63, v59, s58
    s_nop 1
    v_mfma_f32_16x16x32_bf16 v[12:15], v[104:107], v[24:27], v[12:15]
    v_perm_b32 v28, v39, v35, s59
    v_perm_b32 v29, v47, v43, s59
    v_perm_b32 v30, v55, v51, s59
    v_perm_b32 v31, v63, v59, s59
    s_nop 1
    v_mfma_f32_16x16x32_bf16 v[12:15], v[108:111], v[28:31], v[12:15]
    s_waitcnt vmcnt(2)
    s_add_u32 s65, s60, 196608
    buffer_load_dwordx4 v[80:83], v1, s[40:43], s65 offen nt
    s_waitcnt vmcnt(2)
    s_add_u32 s65, s60, 197632
    buffer_load_dwordx4 v[84:87], v1, s[40:43], s65 offen nt
    s_waitcnt vmcnt(2)
    s_add_u32 s65, s60, 229376
    buffer_load_dwordx4 v[88:91], v1, s[40:43], s65 offen nt
    s_waitcnt vmcnt(2)
    s_add_u32 s65, s60, 230400
    buffer_load_dwordx4 v[92:95], v1, s[40:43], s65 offen nt
    s_waitcnt vmcnt(6)
    v_perm_b32 v32, v68, v64, s58
    v_perm_b32 v36, v68, v64, s59
    v_perm_b32 v40, v69, v65, s58
    v_perm_b32 v44, v69, v65, s59
    v_perm_b32 v48, v70, v66, s58
    v_perm_b32 v52, v70, v66, s59
    v_perm_b32 v56, v71, v67, s58
    v_perm_b32 v60, v71, v67, s59
    s_waitcnt vmcnt(4)
    v_perm_b32 v33, v76, v72, s58
    v_perm_b32 v37, v76, v72, s59
    v_perm_b32 v41, v77, v73, s58
    v_perm_b32 v45, v77, v73, s59
    v_perm_b32 v49, v78, v74, s58
    v_perm_b32 v53, v78, v74, s59
    v_perm_b32 v57, v79, v75, s58
    v_perm_b32 v61, v79, v75, s59
    s_waitcnt vmcnt(2)
    v_perm_b32 v34, v84, v80, s58
    v_perm_b32 v38, v84, v80, s59
    v_perm_b32 v42, v85, v81, s58
    v_perm_b32 v46, v85, v81, s59
    v_perm_b32 v50, v86, v82, s58
    v_perm_b32 v54, v86, v82, s59
    v_perm_b32 v58, v87, v83, s58
    v_perm_b32 v62, v87, v83, s59
    s_waitcnt vmcnt(0)
    v_perm_b32 v35, v92, v88, s58
    v_perm_b32 v39, v92, v88, s59
    v_perm_b32 v43, v93, v89, s58
    v_perm_b32 v47, v93, v89, s59
    v_perm_b32 v51, v94, v90, s58
    v_perm_b32 v55, v94, v90, s59
    v_perm_b32 v59, v95, v91, s58
    v_perm_b32 v63, v95, v91, s59
    v_mfma_f32_16x16x32_bf16 v[8:11], v[112:115], v[32:35], v[8:11]
    v_mfma_f32_16x16x32_bf16 v[12:15], v[112:115], v[48:51], v[12:15]
    v_mfma_f32_16x16x32_bf16 v[8:11], v[116:119], v[36:39], v[8:11]
    v_mfma_f32_16x16x32_bf16 v[12:15], v[116:119], v[52:55], v[12:15]
    v_mfma_f32_16x16x32_bf16 v[8:11], v[120:123], v[40:43], v[8:11]
    v_mfma_f32_16x16x32_bf16 v[12:15], v[120:123], v[56:59], v[12:15]
    v_mfma_f32_16x16x32_bf16 v[8:11], v[124:127], v[44:47], v[8:11]
    v_mfma_f32_16x16x32_bf16 v[12:15], v[124:127], v[60:63], v[12:15]
    s_nop 6
    ds_write_b128 v5, v[8:11]
    ds_write_b128 v5, v[12:15] offset:16
    s_waitcnt lgkmcnt(0)
    s_barrier
    s_cmp_ge_u32 s3, 4
    s_cbranch_scc1 L_aend_19
    ds_read_b128 v[16:19], v4 offset:768
    ds_read_b64 v[32:33], v7 offset:0
    ds_read_b64 v[34:35], v7 offset:2048
    ds_read_b64 v[36:37], v7 offset:4096
    ds_read_b64 v[38:39], v7 offset:6144
    ds_read_b128 v[20:23], v4 offset:784
    ds_read_b64 v[40:41], v7 offset:8192
    ds_read_b64 v[42:43], v7 offset:10240
    ds_read_b64 v[44:45], v7 offset:12288
    ds_read_b64 v[46:47], v7 offset:14336
    ds_read_b128 v[24:27], v4 offset:800
    ds_read_b64 v[48:49], v7 offset:16384
    ds_read_b64 v[50:51], v7 offset:18432
    ds_read_b64 v[52:53], v7 offset:20480
    ds_read_b64 v[54:55], v7 offset:22528
    ds_read_b128 v[28:31], v4 offset:816
    ds_read_b64 v[56:57], v7 offset:24576
    ds_read_b64 v[58:59], v7 offset:26624
    ds_read_b64 v[60:61], v7 offset:28672
    ds_read_b64 v[62:63], v7 offset:30720
    v_mov_b32 v9, s56
    s_waitcnt lgkmcnt(15)
    v_pk_mul_f32 v[64:65], v[32:33], v[16:17] op_sel_hi:[1,0]
    v_pk_mul_f32 v[66:67], v[34:35], v[16:17] op_sel:[0,1] op_sel_hi:[1,1]
    v_pk_mul_f32 v[68:69], v[36:37], v[18:19] op_sel_hi:[1,0]
    v_pk_mul_f32 v[70:71], v[38:39], v[18:19] op_sel:[0,1] op_sel_hi:[1,1]
    s_waitcnt lgkmcnt(10)
    v_pk_fma_f32 v[64:65], v[40:41], v[20:21], v[64:65] op_sel_hi:[1,0,1]
    v_pk_fma_f32 v[66:67], v[42:43], v[20:21], v[66:67] op_sel:[0,1,0] op_sel_hi:[1,1,1]
    v_pk_fma_f32 v[68:69], v[44:45], v[22:23], v[68:69] op_sel_hi:[1,0,1]
    v_pk_fma_f32 v[70:71], v[46:47], v[22:23], v[70:71] op_sel:[0,1,0] op_sel_hi:[1,1,1]
    s_waitcnt lgkmcnt(5)
    v_pk_fma_f32 v[64:65], v[48:49], v[24:25], v[64:65] op_sel_hi:[1,0,1]
    v_pk_fma_f32 v[66:67], v[50:51], v[24:25], v[66:67] op_sel:[0,1,0] op_sel_hi:[1,1,1]
    v_pk_fma_f32 v[68:69], v[52:53], v[26:27], v[68:69] op_sel_hi:[1,0,1]
    v_pk_fma_f32 v[70:71], v[54:55], v[26:27], v[70:71] op_sel:[0,1,0] op_sel_hi:[1,1,1]
    s_waitcnt lgkmcnt(0)
    v_pk_fma_f32 v[64:65], v[56:57], v[28:29], v[64:65] op_sel_hi:[1,0,1]
    v_pk_fma_f32 v[66:67], v[58:59], v[28:29], v[66:67] op_sel:[0,1,0] op_sel_hi:[1,1,1]
    v_pk_fma_f32 v[68:69], v[60:61], v[30:31], v[68:69] op_sel_hi:[1,0,1]
    v_pk_fma_f32 v[70:71], v[62:63], v[30:31], v[70:71] op_sel:[0,1,0] op_sel_hi:[1,1,1]
    v_pk_add_f32 v[64:65], v[64:65], v[66:67]
    v_pk_add_f32 v[68:69], v[68:69], v[70:71]
    v_pk_add_f32 v[32:33], v[64:65], v[68:69]
    v_cvt_pk_bf16_f32 v8, v32, v33
    buffer_store_dwordx2 v[8:9], v6, s[32:35], s64 offen
    s_add_u32 s53, s64, 1048576
    buffer_store_dwordx2 v[8:9], v6, s[32:35], s53 offen sc1
L_aend_19:
    s_endpgm
L_b:
    s_sub_u32 s61, s2, 64
    s_and_b32 s69, s3, 3
    v_lshlrev_b32 v1, 4, v0
    s_lshl_b32 s60, s61, 18
    s_lshl_b32 s66, s69, 10
    s_add_u32 s60, s60, s66
    s_lshl_b32 s64, s69, 6
    v_xor_b32 v48, s64, v1
    v_xor_b32 v49, 16, v48
    v_xor_b32 v50, 32, v48
    v_xor_b32 v51, 48, v48
    s_waitcnt lgkmcnt(0)
    s_load_dword s56, s[30:31], 0
    s_mov_b32 s36, s16
    s_mov_b32 s37, s17
    s_mov_b32 s38, 0x1000000
    s_mov_b32 s39, 0x20000
    s_mov_b32 s32, s30
    s_mov_b32 s33, s31
    s_mov_b32 s34, 0x10000000
    s_mov_b32 s35, 0x20000
    s_cmp_ge_u32 s3, 4
    s_cbranch_scc1 L_nld_20
    s_add_u32 m0, s66, 0
    s_add_u32 s64, s60, 0
    buffer_load_dwordx4 v48, s[36:39], s64 offen nt lds
    s_add_u32 m0, s66, 4096
    s_add_u32 s64, s60, 4096
    buffer_load_dwordx4 v49, s[36:39], s64 offen nt lds
    s_add_u32 m0, s66, 8192
    s_add_u32 s64, s60, 8192
    buffer_load_dwordx4 v50, s[36:39], s64 offen nt lds
    s_add_u32 m0, s66, 12288
    s_add_u32 s64, s60, 12288
    buffer_load_dwordx4 v51, s[36:39], s64 offen nt lds
    s_add_u32 m0, s66, 16384
    s_add_u32 s64, s60, 16384
    buffer_load_dwordx4 v48, s[36:39], s64 offen nt lds
    s_add_u32 m0, s66, 20480
    s_add_u32 s64, s60, 20480
    buffer_load_dwordx4 v49, s[36:39], s64 offen nt lds
    s_add_u32 m0, s66, 24576
    s_add_u32 s64, s60, 24576
    buffer_load_dwordx4 v50, s[36:39], s64 offen nt lds
    s_add_u32 m0, s66, 28672
    s_add_u32 s64, s60, 28672
    buffer_load_dwordx4 v51, s[36:39], s64 offen nt lds
L_nld_20:
    v_and_b32 v2, 15, v0
    v_lshrrev_b32 v3, 4, v0
    v_bfe_u32 v21, v0, 2, 2
    v_lshrrev_b32 v22, 5, v0
    v_lshl_add_u32 v23, v22, 2, v21
    v_lshlrev_b32 v23, 10, v23
    v_lshl_or_b32 v24, v21, 2, v22
    v_bfe_u32 v25, v0, 4, 1
    v_bfe_u32 v26, v0, 1, 1
    v_lshl_or_b32 v25, v25, 1, v26
    s_lshl_b32 s64, s3, 2
    v_or_b32 v25, s64, v25
    v_xor_b32 v25, v25, v24
    v_lshl_add_u32 v8, v25, 4, v23
    v_and_b32 v26, 1, v0
    v_lshl_add_u32 v8, v26, 3, v8
    v_xor_b32 v9, 32, v8
    v_add_u32 v9, 8192, v9
    v_add_u32 v10, 0x10000, v8
    v_add_u32 v11, 0x10000, v9
    v_add_u32 v12, 131072, v1
    v_and_b32 v4, 31, v0
    v_mul_u32_u24 v4, 1040, v4
    v_lshl_add_u32 v4, v22, 3, v4
    s_lshl_b32 s64, s3, 6
    v_add_u32 v4, s64, v4
    s_mul_i32 s64, s3, 2080
    v_add_u32 v5, s64, v1
    v_mul_u32_u24 v6, 16384, v3
    v_lshl_add_u32 v6, v2, 4, v6
    v_and_b32 v23, 3, v0
    v_lshl_or_b32 v23, v23, 2, v21
    v_and_b32 v24, 1, v3
    v_lshlrev_b32 v24, 3, v24
    v_xor_b32 v23, v23, v24
    v_lshlrev_b32 v13, 4, v23
    v_lshl_add_u32 v13, v22, 8, v13
    v_lshl_add_u32 v13, v2, 10, v13
    s_lshr_b32 s64, s3, 1
    s_lshl_b32 s64, s64, 14
    s_and_b32 s68, s3, 1
    s_lshl_b32 s65, s68, 9
    s_add_u32 s64, s64, s65
    s_add_u32 s65, s65, 131072
    v_add_u32 v14, s65, v13
    v_add_u32 v13, s64, v13
    s_lshr_b32 s44, s61, 5
    s_lshl_b32 s44, s44, 15
    s_lshl_b32 s45, s69, 10
    s_add_u32 s44, s44, s45
    s_add_u32 s44, s44, 131072
    s_add_u32 s45, s45, 131072
    s_waitcnt lgkmcnt(0)
    s_mul_i32 s56, s56, 1664525
    s_add_u32 s56, s56, 1013904223
    s_mov_b32 s28, 0x03020104
    s_and_b32 s29, s56, 0xff
    s_mov_b32 s40, s8
    s_mov_b32 s41, s9
    s_mov_b32 s42, 0x2000000
    s_mov_b32 s43, 0x20000
    s_lshr_b32 s64, s61, 3
    s_lshl_b32 s64, s64, 1
    s_lshr_b32 s65, s3, 3
    s_add_u32 s64, s64, s65
    s_lshr_b32 s65, s64, 3
    s_lshl_b32 s65, s65, 3
    s_and_b32 s46, s61, 7
    s_add_u32 s65, s65, s46
    s_lshl_b32 s65, s65, 3
    s_and_b32 s64, s64, 7
    s_add_u32 s64, s64, s65
    s_lshl_b32 s46, s64, 18
    s_and_b32 s65, s3, 7
    s_lshl_b32 s65, s65, 13
    s_add_u32 s46, s46, s65
    s_cmp_ge_u32 s3, 4
    s_cbranch_scc1 L_nld_21
    s_waitcnt vmcnt(7)
    s_add_u32 m0, s66, 32768
    s_add_u32 s64, s60, 32768
    buffer_load_dwordx4 v48, s[36:39], s64 offen nt lds
    s_waitcnt vmcnt(7)
    s_add_u32 m0, s66, 36864
    s_add_u32 s64, s60, 36864
    buffer_load_dwordx4 v49, s[36:39], s64 offen nt lds
    s_waitcnt vmcnt(7)
    s_add_u32 m0, s66, 40960
    s_add_u32 s64, s60, 40960
    buffer_load_dwordx4 v50, s[36:39], s64 offen nt lds
    s_waitcnt vmcnt(7)
    s_add_u32 m0, s66, 45056
    s_add_u32 s64, s60, 45056
    buffer_load_dwordx4 v51, s[36:39], s64 offen nt lds
    s_waitcnt vmcnt(7)
    s_add_u32 m0, s66, 49152
    s_add_u32 s64, s60, 49152
    buffer_load_dwordx4 v48, s[36:39], s64 offen nt lds
    s_waitcnt vmcnt(7)
    s_add_u32 m0, s66, 53248
    s_add_u32 s64, s60, 53248
    buffer_load_dwordx4 v49, s[36:39], s64 offen nt lds
    s_waitcnt vmcnt(7)
    s_add_u32 m0, s66, 57344
    s_add_u32 s64, s60, 57344
    buffer_load_dwordx4 v50, s[36:39], s64 offen nt lds
    s_waitcnt vmcnt(7)
    s_add_u32 m0, s66, 61440
    s_add_u32 s64, s60, 61440
    buffer_load_dwordx4 v51, s[36:39], s64 offen nt lds
    s_waitcnt vmcnt(7)
    s_add_u32 m0, s66, 65536
    s_add_u32 s64, s60, 65536
    buffer_load_dwordx4 v48, s[36:39], s64 offen nt lds
    s_waitcnt vmcnt(7)
    s_add_u32 m0, s66, 69632
    s_add_u32 s64, s60, 69632
    buffer_load_dwordx4 v49, s[36:39], s64 offen nt lds
    s_waitcnt vmcnt(7)
    s_add_u32 m0, s66, 73728
    s_add_u32 s64, s60, 73728
    buffer_load_dwordx4 v50, s[36:39], s64 offen nt lds
    s_waitcnt vmcnt(7)
    s_add_u32 m0, s66, 77824
    s_add_u32 s64, s60, 77824
    buffer_load_dwordx4 v51, s[36:39], s64 offen nt lds
    s_waitcnt vmcnt(7)
    s_add_u32 m0, s66, 81920
    s_add_u32 s64, s60, 81920
    buffer_load_dwordx4 v48, s[36:39], s64 offen nt lds
    s_waitcnt vmcnt(7)
    s_add_u32 m0, s66, 86016
    s_add_u32 s64, s60, 86016
    buffer_load_dwordx4 v49, s[36:39], s64 offen nt lds
    s_waitcnt vmcnt(7)
    s_add_u32 m0, s66, 90112
    s_add_u32 s64, s60, 90112
    buffer_load_dwordx4 v50, s[36:39], s64 offen nt lds
    s_waitcnt vmcnt(7)
    s_add_u32 m0, s66, 94208
    s_add_u32 s64, s60, 94208
    buffer_load_dwordx4 v51, s[36:39], s64 offen nt lds
L_nld_21:
    s_barrier
    ds_read_b64_tr_b16 v[64:65], v8 offset:0
    ds_read_b64_tr_b16 v[66:67], v9 offset:0
    ds_read_b64_tr_b16 v[68:69], v8 offset:16384
    ds_read_b64_tr_b16 v[70:71], v9 offset:16384
    ds_read_b64_tr_b16 v[72:73], v8 offset:32768
    ds_read_b64_tr_b16 v[74:75], v9 offset:32768
    ds_read_b64_tr_b16 v[76:77], v8 offset:49152
    ds_read_b64_tr_b16 v[78:79], v9 offset:49152
    s_cmp_ge_u32 s3, 8
    s_cbranch_scc1 L_nxs_22
    v_xor_b32 v16, 0, v13
    ds_read_b128 v[96:99], v16
    v_xor_b32 v17, 16, v13
    ds_read_b128 v[100:103], v17
    v_xor_b32 v18, 32, v13
    ds_read_b128 v[104:107], v18
    v_xor_b32 v19, 48, v13
    ds_read_b128 v[108:111], v19
    v_xor_b32 v16, 64, v13
    ds_read_b128 v[112:115], v16
    v_xor_b32 v17, 80, v13
    ds_read_b128 v[116:119], v17
    v_xor_b32 v18, 96, v13
    ds_read_b128 v[120:123], v18
    v_xor_b32 v19, 112, v13
    ds_read_b128 v[124:127], v19
L_nxs_22:
    s_waitcnt lgkmcnt(0)
    s_barrier
    s_cmp_ge_u32 s3, 4
    s_cbranch_scc1 L_nld_23
    s_waitcnt vmcnt(7)
    s_add_u32 m0, s66, 98304
    s_add_u32 s64, s60, 98304
    buffer_load_dwordx4 v48, s[36:39], s64 offen nt lds
    s_waitcnt vmcnt(7)
    s_add_u32 m0, s66, 102400
    s_add_u32 s64, s60, 102400
    buffer_load_dwordx4 v49, s[36:39], s64 offen nt lds
    s_waitcnt vmcnt(7)
    s_add_u32 m0, s66, 106496
    s_add_u32 s64, s60, 106496
    buffer_load_dwordx4 v50, s[36:39], s64 offen nt lds
    s_waitcnt vmcnt(7)
    s_add_u32 m0, s66, 110592
    s_add_u32 s64, s60, 110592
    buffer_load_dwordx4 v51, s[36:39], s64 offen nt lds
    s_waitcnt vmcnt(7)
    s_add_u32 m0, s66, 114688
    s_add_u32 s64, s60, 114688
    buffer_load_dwordx4 v48, s[36:39], s64 offen nt lds
    s_waitcnt vmcnt(7)
    s_add_u32 m0, s66, 118784
    s_add_u32 s64, s60, 118784
    buffer_load_dwordx4 v49, s[36:39], s64 offen nt lds
    s_waitcnt vmcnt(7)
    s_add_u32 m0, s66, 122880
    s_add_u32 s64, s60, 122880
    buffer_load_dwordx4 v50, s[36:39], s64 offen nt lds
    s_waitcnt vmcnt(7)
    s_add_u32 m0, s66, 126976
    s_add_u32 s64, s60, 126976
    buffer_load_dwordx4 v51, s[36:39], s64 offen nt lds
    s_waitcnt vmcnt(7)
    s_add_u32 m0, s66, 0
    s_add_u32 s64, s60, 131072
    buffer_load_dwordx4 v48, s[36:39], s64 offen nt lds
    s_waitcnt vmcnt(7)
    s_add_u32 m0, s66, 4096
    s_add_u32 s64, s60, 135168
    buffer_load_dwordx4 v49, s[36:39], s64 offen nt lds
    s_waitcnt vmcnt(7)
    s_add_u32 m0, s66, 8192
    s_add_u32 s64, s60, 139264
    buffer_load_dwordx4 v50, s[36:39], s64 offen nt lds
    s_waitcnt vmcnt(7)
    s_add_u32 m0, s66, 12288
    s_add_u32 s64, s60, 143360
    buffer_load_dwordx4 v51, s[36:39], s64 offen nt lds
    s_waitcnt vmcnt(7)
    s_add_u32 m0, s66, 16384
    s_add_u32 s64, s60, 147456
    buffer_load_dwordx4 v48, s[36:39], s64 offen nt lds
    s_waitcnt vmcnt(7)
    s_add_u32 m0, s66, 20480
    s_add_u32 s64, s60, 151552
    buffer_load_dwordx4 v49, s[36:39], s64 offen nt lds
    s_waitcnt vmcnt(7)
    s_add_u32 m0, s66, 24576
    s_add_u32 s64, s60, 155648
    buffer_load_dwordx4 v50, s[36:39], s64 offen nt lds
    s_waitcnt vmcnt(7)
    s_add_u32 m0, s66, 28672
    s_add_u32 s64, s60, 159744
    buffer_load_dwordx4 v51, s[36:39], s64 offen nt lds
L_nld_23:
    s_barrier
    ds_read_b64_tr_b16 v[80:81], v10 offset:0
    ds_read_b64_tr_b16 v[82:83], v11 offset:0
    ds_read_b64_tr_b16 v[84:85], v10 offset:16384
    ds_read_b64_tr_b16 v[86:87], v11 offset:16384
    ds_read_b64_tr_b16 v[88:89], v10 offset:32768
    ds_read_b64_tr_b16 v[90:91], v11 offset:32768
    ds_read_b64_tr_b16 v[92:93], v10 offset:49152
    ds_read_b64_tr_b16 v[94:95], v11 offset:49152
    s_cmp_lt_u32 s3, 8
    s_cbranch_scc1 L_nxs_24
    v_xor_b32 v16, 0, v13
    ds_read_b128 v[96:99], v16
    v_xor_b32 v17, 16, v13
    ds_read_b128 v[100:103], v17
    v_xor_b32 v18, 32, v13
    ds_read_b128 v[104:107], v18
    v_xor_b32 v19, 48, v13
    ds_read_b128 v[108:111], v19
    v_xor_b32 v16, 64, v13
    ds_read_b128 v[112:115], v16
    v_xor_b32 v17, 80, v13
    ds_read_b128 v[116:119], v17
    v_xor_b32 v18, 96, v13
    ds_read_b128 v[120:123], v18
    v_xor_b32 v19, 112, v13
    ds_read_b128 v[124:127], v19
L_nxs_24:
    s_waitcnt lgkmcnt(0)
    s_barrier
    s_cmp_ge_u32 s3, 4
    s_cbranch_scc1 L_nld_25
    s_waitcnt vmcnt(7)
    s_add_u32 m0, s66, 32768
    s_add_u32 s64, s60, 163840
    buffer_load_dwordx4 v48, s[36:39], s64 offen nt lds
    s_waitcnt vmcnt(7)
    s_add_u32 m0, s66, 36864
    s_add_u32 s64, s60, 167936
    buffer_load_dwordx4 v49, s[36:39], s64 offen nt lds
    s_waitcnt vmcnt(7)
    s_add_u32 m0, s66, 40960
    s_add_u32 s64, s60, 172032
    buffer_load_dwordx4 v50, s[36:39], s64 offen nt lds
    s_waitcnt vmcnt(7)
    s_add_u32 m0, s66, 45056
    s_add_u32 s64, s60, 176128
    buffer_load_dwordx4 v51, s[36:39], s64 offen nt lds
L_nld_25:
    s_barrier
    s_cmp_ge_u32 s3, 4
    s_cbranch_scc1 L_nld_26
    s_waitcnt vmcnt(7)
    s_add_u32 m0, s66, 49152
    s_add_u32 s64, s60, 180224
    buffer_load_dwordx4 v48, s[36:39], s64 offen nt lds
    s_waitcnt vmcnt(7)
    s_add_u32 m0, s66, 53248
    s_add_u32 s64, s60, 184320
    buffer_load_dwordx4 v49, s[36:39], s64 offen nt lds
    s_waitcnt vmcnt(7)
    s_add_u32 m0, s66, 57344
    s_add_u32 s64, s60, 188416
    buffer_load_dwordx4 v50, s[36:39], s64 offen nt lds
    s_waitcnt vmcnt(7)
    s_add_u32 m0, s66, 61440
    s_add_u32 s64, s60, 192512
    buffer_load_dwordx4 v51, s[36:39], s64 offen nt lds
    s_waitcnt vmcnt(7)
    s_add_u32 m0, s66, 65536
    s_add_u32 s64, s60, 196608
    buffer_load_dwordx4 v48, s[36:39], s64 offen nt lds
    s_waitcnt vmcnt(7)
    s_add_u32 m0, s66, 69632
    s_add_u32 s64, s60, 200704
    buffer_load_dwordx4 v49, s[36:39], s64 offen nt lds
    s_waitcnt vmcnt(7)
    s_add_u32 m0, s66, 73728
    s_add_u32 s64, s60, 204800
    buffer_load_dwordx4 v50, s[36:39], s64 offen nt lds
    s_waitcnt vmcnt(7)
    s_add_u32 m0, s66, 77824
    s_add_u32 s64, s60, 208896
    buffer_load_dwordx4 v51, s[36:39], s64 offen nt lds
    s_waitcnt vmcnt(7)
    s_add_u32 m0, s66, 81920
    s_add_u32 s64, s60, 212992
    buffer_load_dwordx4 v48, s[36:39], s64 offen nt lds
    s_waitcnt vmcnt(7)
    s_add_u32 m0, s66, 86016
    s_add_u32 s64, s60, 217088
    buffer_load_dwordx4 v49, s[36:39], s64 offen nt lds
    s_waitcnt vmcnt(7)
    s_add_u32 m0, s66, 90112
    s_add_u32 s64, s60, 221184
    buffer_load_dwordx4 v50, s[36:39], s64 offen nt lds
    s_waitcnt vmcnt(7)
    s_add_u32 m0, s66, 94208
    s_add_u32 s64, s60, 225280
    buffer_load_dwordx4 v51, s[36:39], s64 offen nt lds
    s_waitcnt vmcnt(7)
    s_add_u32 m0, s66, 98304
    s_add_u32 s64, s60, 229376
    buffer_load_dwordx4 v48, s[36:39], s64 offen nt lds
    s_waitcnt vmcnt(7)
    s_add_u32 m0, s66, 102400
    s_add_u32 s64, s60, 233472
    buffer_load_dwordx4 v49, s[36:39], s64 offen nt lds
    s_waitcnt vmcnt(7)
    s_add_u32 m0, s66, 106496
    s_add_u32 s64, s60, 237568
    buffer_load_dwordx4 v50, s[36:39], s64 offen nt lds
    s_waitcnt vmcnt(7)
    s_add_u32 m0, s66, 110592
    s_add_u32 s64, s60, 241664
    buffer_load_dwordx4 v51, s[36:39], s64 offen nt lds
    s_waitcnt vmcnt(7)
    s_add_u32 m0, s66, 114688
    s_add_u32 s64, s60, 245760
    buffer_load_dwordx4 v48, s[36:39], s64 offen nt lds
    s_waitcnt vmcnt(7)
    s_add_u32 m0, s66, 118784
    s_add_u32 s64, s60, 249856
    buffer_load_dwordx4 v49, s[36:39], s64 offen nt lds
    s_waitcnt vmcnt(7)
    s_add_u32 m0, s66, 122880
    s_add_u32 s64, s60, 253952
    buffer_load_dwordx4 v50, s[36:39], s64 offen nt lds
    s_waitcnt vmcnt(7)
    s_add_u32 m0, s66, 126976
    s_add_u32 s64, s60, 258048
    buffer_load_dwordx4 v51, s[36:39], s64 offen nt lds
L_nld_26:
    s_lshr_b32 s64, s3, 2
    s_cmp_lg_u32 s64, 1
    s_cbranch_scc1 L_nq_27
    v_lshlrev_b32 v20, 7, v0
    s_mov_b32 s64, 4096
    s_setprio 2
    s_mov_b32 s57, 200000
L_poll_28:
    buffer_load_dword v21, v20, s[32:35], s64 offen sc1
    s_waitcnt vmcnt(0)
L_chk_30:
    v_cmp_ne_u32 vcc, s56, v21
    s_cmp_eq_u64 vcc, 0
    s_cbranch_scc1 L_ok_29
    s_sleep 4
    s_sub_u32 s57, s57, 1
    s_cmp_lg_u32 s57, 0
    s_cbranch_scc1 L_poll_28
L_ok_29:
    s_add_u32 m0, s45, 0
    s_add_u32 s64, s44, 0
    buffer_load_dwordx4 v48, s[32:35], s64 offen sc1 lds
    s_add_u32 m0, s45, 4096
    s_add_u32 s64, s44, 4096
    buffer_load_dwordx4 v49, s[32:35], s64 offen sc1 lds
    s_add_u32 m0, s45, 8192
    s_add_u32 s64, s44, 8192
    buffer_load_dwordx4 v50, s[32:35], s64 offen sc1 lds
    s_add_u32 m0, s45, 12288
    s_add_u32 s64, s44, 12288
    buffer_load_dwordx4 v51, s[32:35], s64 offen sc1 lds
    s_add_u32 m0, s45, 16384
    s_add_u32 s64, s44, 16384
    buffer_load_dwordx4 v48, s[32:35], s64 offen sc1 lds
    s_add_u32 m0, s45, 20480
    s_add_u32 s64, s44, 20480
    buffer_load_dwordx4 v49, s[32:35], s64 offen sc1 lds
    s_add_u32 m0, s45, 24576
    s_add_u32 s64, s44, 24576
    buffer_load_dwordx4 v50, s[32:35], s64 offen sc1 lds
    s_add_u32 m0, s45, 28672
    s_add_u32 s64, s44, 28672
    buffer_load_dwordx4 v51, s[32:35], s64 offen sc1 lds
    s_setprio 0
    s_waitcnt vmcnt(0)
L_nq_27:
    s_waitcnt lgkmcnt(0)
    s_barrier
    v_xor_b32 v56, 0, v14
    ds_read_b128 v[32:35], v56
    ds_read_b128 v[36:39], v56 offset:16384
    v_xor_b32 v57, 16, v14
    ds_read_b128 v[40:43], v57
    ds_read_b128 v[44:47], v57 offset:16384
    v_xor_b32 v58, 32, v14
    ds_read_b128 v[48:51], v58
    ds_read_b128 v[52:55], v58 offset:16384
    s_waitcnt lgkmcnt(4)
    v_mfma_f32_16x16x32_bf16 v[16:19], v[96:99], v[32:35], 0
    v_mfma_f32_16x16x32_bf16 v[20:23], v[96:99], v[36:39], 0
    v_xor_b32 v56, 48, v14
    ds_read_b128 v[32:35], v56
    ds_read_b128 v[36:39], v56 offset:16384
    s_waitcnt lgkmcnt(4)
    v_mfma_f32_16x16x32_bf16 v[16:19], v[100:103], v[40:43], v[16:19]
    v_mfma_f32_16x16x32_bf16 v[20:23], v[100:103], v[44:47], v[20:23]
    v_xor_b32 v57, 64, v14
    ds_read_b128 v[40:43], v57
    ds_read_b128 v[44:47], v57 offset:16384
    s_waitcnt lgkmcnt(4)
    v_mfma_f32_16x16x32_bf16 v[16:19], v[104:107], v[48:51], v[16:19]
    v_mfma_f32_16x16x32_bf16 v[20:23], v[104:107], v[52:55], v[20:23]
    v_xor_b32 v58, 80, v14
    ds_read_b128 v[48:51], v58
    ds_read_b128 v[52:55], v58 offset:16384
    s_waitcnt lgkmcnt(4)
    v_mfma_f32_16x16x32_bf16 v[16:19], v[108:111], v[32:35], v[16:19]
    v_mfma_f32_16x16x32_bf16 v[20:23], v[108:111], v[36:39], v[20:23]
    v_xor_b32 v56, 96, v14
    ds_read_b128 v[32:35], v56
    ds_read_b128 v[36:39], v56 offset:16384
    s_waitcnt lgkmcnt(4)
    v_mfma_f32_16x16x32_bf16 v[16:19], v[112:115], v[40:43], v[16:19]
    v_mfma_f32_16x16x32_bf16 v[20:23], v[112:115], v[44:47], v[20:23]
    v_xor_b32 v57, 112, v14
    ds_read_b128 v[40:43], v57
    ds_read_b128 v[44:47], v57 offset:16384
    s_waitcnt lgkmcnt(4)
    v_mfma_f32_16x16x32_bf16 v[16:19], v[116:119], v[48:51], v[16:19]
    v_mfma_f32_16x16x32_bf16 v[20:23], v[116:119], v[52:55], v[20:23]
    s_waitcnt lgkmcnt(2)
    v_mfma_f32_16x16x32_bf16 v[16:19], v[120:123], v[32:35], v[16:19]
    v_mfma_f32_16x16x32_bf16 v[20:23], v[120:123], v[36:39], v[20:23]
    s_waitcnt lgkmcnt(0)
    v_mfma_f32_16x16x32_bf16 v[16:19], v[124:127], v[40:43], v[16:19]
    v_mfma_f32_16x16x32_bf16 v[20:23], v[124:127], v[44:47], v[20:23]
    v_xor_b32 v56, 0, v14
    ds_read_b128 v[32:35], v56
    ds_read_b128 v[36:39], v56 offset:16384
    v_xor_b32 v57, 16, v14
    ds_read_b128 v[40:43], v57
    ds_read_b128 v[44:47], v57 offset:16384
    v_xor_b32 v58, 32, v14
    ds_read_b128 v[48:51], v58
    ds_read_b128 v[52:55], v58 offset:16384
    s_waitcnt vmcnt(0)
    s_barrier
    v_xor_b32 v60, 0, v13
    ds_read_b128 v[96:99], v60
    v_xor_b32 v61, 16, v13
    ds_read_b128 v[100:103], v61
    v_xor_b32 v62, 32, v13
    ds_read_b128 v[104:107], v62
    v_xor_b32 v63, 48, v13
    ds_read_b128 v[108:111], v63
    v_xor_b32 v60, 64, v13
    ds_read_b128 v[112:115], v60
    v_xor_b32 v61, 80, v13
    ds_read_b128 v[116:119], v61
    v_xor_b32 v62, 96, v13
    ds_read_b128 v[120:123], v62
    v_xor_b32 v63, 112, v13
    ds_read_b128 v[124:127], v63
    s_waitcnt lgkmcnt(7)
    v_mfma_f32_16x16x32_bf16 v[24:27], v[96:99], v[32:35], 0
    v_mfma_f32_16x16x32_bf16 v[28:31], v[96:99], v[36:39], 0
    v_xor_b32 v56, 48, v14
    ds_read_b128 v[32:35], v56
    ds_read_b128 v[36:39], v56 offset:16384
    s_waitcnt lgkmcnt(8)
    v_mfma_f32_16x16x32_bf16 v[24:27], v[100:103], v[40:43], v[24:27]
    v_mfma_f32_16x16x32_bf16 v[28:31], v[100:103], v[44:47], v[28:31]
    v_xor_b32 v57, 64, v14
    ds_read_b128 v[40:43], v57
    ds_read_b128 v[44:47], v57 offset:16384
    s_waitcnt lgkmcnt(9)
    v_mfma_f32_16x16x32_bf16 v[24:27], v[104:107], v[48:51], v[24:27]
    v_mfma_f32_16x16x32_bf16 v[28:31], v[104:107], v[52:55], v[28:31]
    v_xor_b32 v58, 80, v14
    ds_read_b128 v[48:51], v58
    ds_read_b128 v[52:55], v58 offset:16384
    s_waitcnt lgkmcnt(4)
    v_mfma_f32_16x16x32_bf16 v[24:27], v[108:111], v[32:35], v[24:27]
    v_mfma_f32_16x16x32_bf16 v[28:31], v[108:111], v[36:39], v[28:31]
    v_xor_b32 v56, 96, v14
    ds_read_b128 v[32:35], v56
    ds_read_b128 v[36:39], v56 offset:16384
    s_waitcnt lgkmcnt(4)
    v_mfma_f32_16x16x32_bf16 v[24:27], v[112:115], v[40:43], v[24:27]
    v_mfma_f32_16x16x32_bf16 v[28:31], v[112:115], v[44:47], v[28:31]
    v_xor_b32 v57, 112, v14
    ds_read_b128 v[40:43], v57
    ds_read_b128 v[44:47], v57 offset:16384
    s_waitcnt lgkmcnt(4)
    v_mfma_f32_16x16x32_bf16 v[24:27], v[116:119], v[48:51], v[24:27]
    v_mfma_f32_16x16x32_bf16 v[28:31], v[116:119], v[52:55], v[28:31]
    s_waitcnt lgkmcnt(2)
    v_mfma_f32_16x16x32_bf16 v[24:27], v[120:123], v[32:35], v[24:27]
    v_mfma_f32_16x16x32_bf16 v[28:31], v[120:123], v[36:39], v[28:31]
    s_waitcnt lgkmcnt(0)
    v_mfma_f32_16x16x32_bf16 v[24:27], v[124:127], v[40:43], v[24:27]
    v_mfma_f32_16x16x32_bf16 v[28:31], v[124:127], v[44:47], v[28:31]
    s_lshl_b32 s64, s68, 3
    s_lshr_b32 s65, s3, 1
    s_add_u32 s64, s64, s65
    s_lshl_b32 s45, s64, 11
    s_xor_b32 s65, s45, 0x4000
    v_add_u32 v56, s65, v12
    v_add_u32 v57, s45, v12
    s_barrier
    s_cmp_eq_u32 s68, 1
    s_cbranch_scc1 L_oy_31
    s_nop 2
    ds_write_b128 v56, v[24:27]
    ds_write_b128 v56, v[28:31] offset:1024
    s_branch L_oj_32
L_oy_31:
    s_nop 2
    ds_write_b128 v56, v[16:19]
    ds_write_b128 v56, v[20:23] offset:1024
    v_mov_b32 v16, v24
    v_mov_b32 v17, v25
    v_mov_b32 v18, v26
    v_mov_b32 v19, v27
    v_mov_b32 v20, v28
    v_mov_b32 v21, v29
    v_mov_b32 v22, v30
    v_mov_b32 v23, v31
L_oj_32:
    s_waitcnt lgkmcnt(0)
    s_barrier
    ds_read_b128 v[24:27], v57
    ds_read_b128 v[28:31], v57 offset:1024
    v_lshrrev_b32 v58, 5, v0
    v_lshl_add_u32 v58, v58, 4, v2
    v_lshlrev_b32 v58, 2, v58
    s_add_u32 s45, s45, 131072
    v_add_u32 v58, s45, v58
    v_lshlrev_b32 v59, 13, v3
    v_lshl_add_u32 v59, v2, 2, v59
    v_add_u32 v59, 131072, v59
    v_add_u32 v61, 64, v59
    v_and_b32 v60, 1, v3
    v_lshlrev_b32 v60, 9, v60
    v_lshl_add_u32 v60, v2, 4, v60
    v_lshrrev_b32 v62, 1, v3
    v_lshl_add_u32 v60, v62, 3, v60
    v_add_u32 v60, s45, v60
    s_waitcnt lgkmcnt(0)
    v_pk_add_f32 v[16:17], v[16:17], v[24:25]
    v_pk_add_f32 v[18:19], v[18:19], v[26:27]
    v_pk_add_f32 v[20:21], v[20:21], v[28:29]
    v_pk_add_f32 v[22:23], v[22:23], v[30:31]
    v_max3_f32 v32, v16, v17, v18
    v_max_f32 v32, v32, v19
    v_max3_f32 v33, v20, v21, v22
    v_max_f32 v33, v33, v23
    s_nop 1
    v_permlane32_swap_b32 v32, v33
    v_max_f32 v32, v32, v33
    v_mov_b32 v33, v32
    s_nop 1
    v_permlane16_swap_b32 v32, v33
    v_max_f32 v32, v32, v33
    ds_write_b32 v58, v32
    s_waitcnt lgkmcnt(0)
    s_barrier
    ds_read2st64_b32 v[36:37], v59 offset0:0 offset1:8
    ds_read2st64_b32 v[38:39], v59 offset0:16 offset1:24
    ds_read2st64_b32 v[40:41], v61 offset0:0 offset1:8
    ds_read2st64_b32 v[42:43], v61 offset0:16 offset1:24
    s_waitcnt lgkmcnt(0)
    v_max3_f32 v32, v36, v37, v38
    v_max_f32 v32, v32, v39
    v_max3_f32 v33, v40, v41, v42
    v_max_f32 v33, v33, v43
    v_mov_b32 v34, v32
    v_mov_b32 v35, v33
    s_nop 0
    v_permlane32_swap_b32 v32, v34
    v_permlane32_swap_b32 v33, v35
    v_max_f32 v32, v32, v34
    v_max_f32 v33, v33, v35
    v_mov_b32 v34, v32
    v_mov_b32 v35, v33
    s_nop 0
    v_permlane16_swap_b32 v32, v34
    v_permlane16_swap_b32 v33, v35
    v_max_f32 v32, v32, v34
    v_max_f32 v33, v33, v35
    v_mul_f32 v32, s71, v32
    v_mul_f32 v33, s71, v33
    v_fma_f32 v16, v16, s71, -v32
    v_fma_f32 v17, v17, s71, -v32
    v_fma_f32 v18, v18, s71, -v32
    v_fma_f32 v19, v19, s71, -v32
    v_fma_f32 v20, v20, s71, -v33
    v_fma_f32 v21, v21, s71, -v33
    v_fma_f32 v22, v22, s71, -v33
    v_fma_f32 v23, v23, s71, -v33
    v_exp_f32 v16, v16
    v_exp_f32 v17, v17
    v_exp_f32 v18, v18
    v_exp_f32 v19, v19
    v_exp_f32 v20, v20
    v_exp_f32 v21, v21
    v_exp_f32 v22, v22
    v_exp_f32 v23, v23
    v_cvt_pk_bf16_f32 v36, v16, v17
    v_cvt_pk_bf16_f32 v37, v18, v19
    ds_write_b64 v60, v[36:37] offset:1024
    v_cvt_pk_bf16_f32 v38, v20, v21
    v_cvt_pk_bf16_f32 v39, v22, v23
    ds_write_b64 v60, v[38:39] offset:1280
    v_pk_add_f32 v[16:17], v[16:17], v[18:19]
    v_pk_add_f32 v[20:21], v[20:21], v[22:23]
    v_add_f32 v96, v16, v17
    v_add_f32 v97, v20, v21
    v_and_b32 v62, 1, v3
    v_cmp_eq_u32 vcc, 1, v62
    s_nop 1
    v_cndmask_b32 v15, v32, v33, vcc
    v_mov_b32 v98, v58
    s_waitcnt lgkmcnt(0)
    s_barrier
    ds_read_b128 v[100:103], v12 offset:1024
    ds_read_b128 v[104:107], v12 offset:3072
    ds_read_b128 v[108:111], v12 offset:5120
    ds_read_b128 v[112:115], v12 offset:7168
    ds_read_b128 v[116:119], v12 offset:9216
    ds_read_b128 v[120:123], v12 offset:11264
    ds_read_b128 v[124:127], v12 offset:13312
    v_permlane32_swap_b32 v96, v97
    v_add_f32 v96, v96, v97
    v_mov_b32 v97, v96
    s_nop 1
    v_permlane16_swap_b32 v96, v97
    v_add_f32 v96, v96, v97
    s_waitcnt lgkmcnt(6)
    v_mfma_f32_32x32x16_bf16 v[16:31], v[64:67], v[100:103], 0
    ds_read_b128 v[100:103], v12 offset:15360
    ds_write_b32 v98, v96 offset:128
    s_waitcnt lgkmcnt(7)
    v_mfma_f32_32x32x16_bf16 v[16:31], v[68:71], v[104:107], v[16:31]
    s_waitcnt lgkmcnt(6)
    v_mfma_f32_32x32x16_bf16 v[16:31], v[72:75], v[108:111], v[16:31]
    s_waitcnt lgkmcnt(5)
    v_mfma_f32_32x32x16_bf16 v[16:31], v[76:79], v[112:115], v[16:31]
    s_waitcnt lgkmcnt(4)
    v_mfma_f32_32x32x16_bf16 v[16:31], v[80:83], v[116:119], v[16:31]
    ds_read_b64_tr_b16 v[32:33], v8 offset:0
    ds_read_b64_tr_b16 v[34:35], v9 offset:0
    ds_read_b128 v[36:39], v12 offset:17408
    s_waitcnt lgkmcnt(6)
    v_mfma_f32_32x32x16_bf16 v[16:31], v[84:87], v[120:123], v[16:31]
    ds_read_b64_tr_b16 v[40:41], v8 offset:16384
    ds_read_b64_tr_b16 v[42:43], v9 offset:16384
    ds_read_b128 v[44:47], v12 offset:19456
    s_waitcnt lgkmcnt(8)
    v_mfma_f32_32x32x16_bf16 v[16:31], v[88:91], v[124:127], v[16:31]
    ds_read_b64_tr_b16 v[48:49], v8 offset:32768
    ds_read_b64_tr_b16 v[50:51], v9 offset:32768
    ds_read_b128 v[52:55], v12 offset:21504
    s_waitcnt lgkmcnt(10)
    v_mfma_f32_32x32x16_bf16 v[16:31], v[92:95], v[100:103], v[16:31]
    ds_read_b64_tr_b16 v[56:57], v8 offset:49152
    ds_read_b64_tr_b16 v[58:59], v9 offset:49152
    ds_read_b128 v[60:63], v12 offset:23552
    s_waitcnt lgkmcnt(9)
    v_mfma_f32_32x32x16_bf16 v[16:31], v[32:35], v[36:39], v[16:31]
    ds_read_b64_tr_b16 v[32:33], v10 offset:0
    ds_read_b64_tr_b16 v[34:35], v11 offset:0
    ds_read_b128 v[36:39], v12 offset:25600
    s_waitcnt lgkmcnt(9)
    v_mfma_f32_32x32x16_bf16 v[16:31], v[40:43], v[44:47], v[16:31]
    ds_read_b64_tr_b16 v[40:41], v10 offset:16384
    ds_read_b64_tr_b16 v[42:43], v11 offset:16384
    ds_read_b128 v[44:47], v12 offset:27648
    s_waitcnt lgkmcnt(9)
    v_mfma_f32_32x32x16_bf16 v[16:31], v[48:51], v[52:55], v[16:31]
    ds_read_b64_tr_b16 v[48:49], v10 offset:32768
    ds_read_b64_tr_b16 v[50:51], v11 offset:32768
    ds_read_b128 v[52:55], v12 offset:29696
    s_waitcnt lgkmcnt(9)
    v_mfma_f32_32x32x16_bf16 v[16:31], v[56:59], v[60:63], v[16:31]
    ds_read_b64_tr_b16 v[56:57], v10 offset:49152
    ds_read_b64_tr_b16 v[58:59], v11 offset:49152
    ds_read_b128 v[60:63], v12 offset:31744
    s_waitcnt lgkmcnt(9)
    v_mfma_f32_32x32x16_bf16 v[16:31], v[32:35], v[36:39], v[16:31]
    s_waitcnt lgkmcnt(6)
    v_mfma_f32_32x32x16_bf16 v[16:31], v[40:43], v[44:47], v[16:31]
    s_waitcnt lgkmcnt(3)
    v_mfma_f32_32x32x16_bf16 v[16:31], v[48:51], v[52:55], v[16:31]
    s_waitcnt lgkmcnt(0)
    v_mfma_f32_32x32x16_bf16 v[16:31], v[56:59], v[60:63], v[16:31]
    s_mul_i32 s64, s3, 131072
    s_lshl_b32 s65, s61, 8
    s_add_u32 s64, s64, s65
    s_add_u32 s64, s64, 4194304
    s_add_u32 s65, s64, 65536
    s_barrier
    s_nop 5
    v_cvt_pk_bf16_f32 v32, v16, v17
    v_cvt_pk_bf16_f32 v33, v18, v19
    ds_write_b64 v4, v[32:33] offset:0
    v_cvt_pk_bf16_f32 v34, v20, v21
    v_cvt_pk_bf16_f32 v35, v22, v23
    ds_write_b64 v4, v[34:35] offset:16
    v_cvt_pk_bf16_f32 v36, v24, v25
    v_cvt_pk_bf16_f32 v37, v26, v27
    ds_write_b64 v4, v[36:37] offset:32
    v_cvt_pk_bf16_f32 v38, v28, v29
    v_cvt_pk_bf16_f32 v39, v30, v31
    ds_write_b64 v4, v[38:39] offset:48
    s_waitcnt lgkmcnt(0)
    s_barrier
    ds_read_b128 v[32:35], v5
    ds_read_b128 v[36:39], v5 offset:1040
    s_waitcnt lgkmcnt(1)
    buffer_store_dwordx4 v[32:35], v6, s[32:35], s64 offen sc1
    s_waitcnt lgkmcnt(0)
    buffer_store_dwordx4 v[36:39], v6, s[32:35], s65 offen sc1
    s_and_b32 s70, s61, 7
    s_lshl_b32 s70, s70, 2
    s_bfe_u32 s64, s61, 0x20003
    s_add_u32 s70, s70, s64
    s_bfe_u32 s68, s61, 0x10005
    s_lshl_b32 s68, s68, 1
    s_bfe_u32 s64, s3, 0x10002
    s_add_u32 s68, s68, s64
    s_lshl_b32 s60, s70, 17
    s_lshl_b32 s64, s69, 15
    s_add_u32 s60, s60, s64
    s_lshl_b32 s64, s68, 8
    s_add_u32 s60, s60, s64
    v_lshlrev_b32 v4, 13, v3
    v_lshl_add_u32 v4, v2, 4, v4
    s_mul_i32 s47, s3, 8448
    s_add_u32 s47, s47, 40960
    v_mov_b32 v48, 120064
    v_mov_b32 v50, 0
    v_mov_b32 v51, 0
    ds_write_b64 v48, v[50:51]
    s_mov_b32 s48, s12
    s_mov_b32 s49, s13
    s_mov_b32 s50, 0x400000
    s_mov_b32 s51, 0x20000
    s_cmp_lg_u32 s3, 8
    s_cbranch_scc1 L_bnf_34
    v_and_b32 v9, 31, v0
    v_lshlrev_b32 v8, 2, v9
    v_add_u32 v8, 131200, v8
    v_lshlrev_b32 v9, 4, v9
    ds_read2st64_b32 v[64:65], v8 offset0:0 offset1:8
    ds_read2st64_b32 v[66:67], v8 offset0:16 offset1:24
    ds_read2st64_b32 v[68:69], v8 offset0:32 offset1:40
    ds_read2st64_b32 v[70:71], v8 offset0:48 offset1:56
    ds_read2st64_b32 v[72:73], v8 offset0:64 offset1:72
    ds_read2st64_b32 v[74:75], v8 offset0:80 offset1:88
    ds_read2st64_b32 v[76:77], v8 offset0:96 offset1:104
    ds_read2st64_b32 v[78:79], v8 offset0:112 offset1:120
    s_lshl_b32 s64, s61, 9
    s_add_u32 s64, s64, 327680
    v_mov_b32 v44, v15
    v_mov_b32 v45, s56
    v_mov_b32 v47, s56
    s_setprio 3
    s_waitcnt lgkmcnt(0)
    v_pk_add_f32 v[64:65], v[64:65], v[72:73]
    v_pk_add_f32 v[66:67], v[66:67], v[74:75]
    v_pk_add_f32 v[68:69], v[68:69], v[76:77]
    v_pk_add_f32 v[70:71], v[70:71], v[78:79]
    v_pk_add_f32 v[64:65], v[64:65], v[68:69]
    v_pk_add_f32 v[66:67], v[66:67], v[70:71]
    v_pk_add_f32 v[64:65], v[64:65], v[66:67]
    v_add_f32 v46, v64, v65
    s_mov_b32 exec_hi, 0
    s_waitcnt vmcnt(0)
    s_barrier
    buffer_store_dwordx4 v[44:47], v9, s[32:35], s64 offen sc1
    s_mov_b64 exec, -1
    s_branch L_bend_33
L_bnf_34:
    s_waitcnt vmcnt(0) lgkmcnt(0)
    s_barrier
    s_cmp_lt_u32 s3, 8
    s_cbranch_scc1 L_boa_35
    s_branch L_bend_33
L_boa_35:
    s_add_u32 m0, s47, 0
    s_add_u32 s64, s60, 0
    buffer_load_dwordx4 v4, s[48:51], s64 offen nt lds
    s_add_u32 m0, s47, 1056
    s_add_u32 s64, s60, 1024
    buffer_load_dwordx4 v4, s[48:51], s64 offen nt lds
    s_add_u32 m0, s47, 2112
    s_add_u32 s64, s60, 2048
    buffer_load_dwordx4 v4, s[48:51], s64 offen nt lds
    s_add_u32 m0, s47, 3168
    s_add_u32 s64, s60, 3072
    buffer_load_dwordx4 v4, s[48:51], s64 offen nt lds
    s_add_u32 m0, s47, 4224
    s_add_u32 s64, s60, 4096
    buffer_load_dwordx4 v4, s[48:51], s64 offen nt lds
    s_add_u32 m0, s47, 5280
    s_add_u32 s64, s60, 5120
    buffer_load_dwordx4 v4, s[48:51], s64 offen nt lds
    s_add_u32 m0, s47, 6336
    s_add_u32 s64, s60, 6144
    buffer_load_dwordx4 v4, s[48:51], s64 offen nt lds
    s_add_u32 m0, s47, 7392
    s_add_u32 s64, s60, 7168
    buffer_load_dwordx4 v4, s[48:51], s64 offen nt lds
    s_lshr_b32 s66, s3, 2
    s_mul_i32 s66, s66, 33792
    s_add_u32 s66, s66, 40960
    v_bfe_u32 v31, v0, 2, 2
    v_mul_u32_u24 v31, 1056, v31
    v_lshl_add_u32 v31, v3, 8, v31
    v_and_b32 v10, 3, v0
    v_lshl_add_u32 v31, v10, 3, v31
    s_lshl_b32 s64, s69, 6
    s_add_u32 s64, s64, s66
    v_add_u32 v31, s64, v31
    v_mul_u32_u24 v6, 272, v2
    v_lshl_add_u32 v3, v3, 4, v6
    v_add_u32 v3, 114688, v3
    v_mov_b32 v29, s56
    v_lshrrev_b32 v7, 5, v0
    v_and_b32 v8, 31, v0
    v_mul_u32_u24 v30, 272, v7
    v_lshl_add_u32 v30, v8, 3, v30
    v_lshlrev_b32 v7, 16, v7
    v_lshl_add_u32 v7, v8, 2, v7
    s_mul_i32 s65, s3, 544
    s_add_u32 s65, s65, 114688
    v_add_u32 v30, s65, v30
    s_lshl_b32 s67, s68, 2
    s_add_u32 s67, s67, s69
    s_lshl_b32 s67, s67, 5
    s_add_u32 s67, s67, s70
    s_lshl_b32 s67, s67, 7
    s_add_u32 s67, s67, 786432
    v_lshlrev_b32 v5, 4, v2
    s_lshl_b32 s64, s70, 8
    s_add_u32 s64, s64, 262144
    s_mov_b32 s57, 200000
L_poll_36:
    buffer_load_dwordx4 v[8:11], v5, s[32:35], s64 offen sc1
    s_waitcnt vmcnt(0)
L_chk_38:
    v_cmp_ne_u32 vcc, s56, v9
    v_cmp_ne_u32 s[62:63], s56, v11
    s_or_b64 vcc, vcc, s[62:63]
    s_cmp_eq_u64 vcc, 0
    s_cbranch_scc1 L_ok_37
    s_sleep 4
    s_sub_u32 s57, s57, 1
    s_cmp_lg_u32 s57, 0
    s_cbranch_scc1 L_poll_36
L_ok_37:
    v_mov_b32 v48, 120064
    v_mov_b32 v49, 1
    s_mov_b64 exec, 1
    ds_add_u32 v48, v49
    s_mov_b64 exec, -1
    v_max_f32_dpp v12, v8, v8 quad_perm:[1,0,3,2] row_mask:0xf bank_mask:0xf
    s_nop 1
    v_max_f32_dpp v12, v12, v12 quad_perm:[2,3,0,1] row_mask:0xf bank_mask:0xf
    s_nop 1
    v_max_f32_dpp v12, v12, v12 row_half_mirror row_mask:0xf bank_mask:0xf
    v_sub_f32 v13, v8, v12
    v_exp_f32 v13, v13
    s_nop 0
    v_mul_f32 v14, v13, v10
    s_nop 1
    v_add_f32_dpp v14, v14, v14 quad_perm:[1,0,3,2] row_mask:0xf bank_mask:0xf
    s_nop 1
    v_add_f32_dpp v14, v14, v14 quad_perm:[2,3,0,1] row_mask:0xf bank_mask:0xf
    s_nop 1
    v_add_f32_dpp v14, v14, v14 row_half_mirror row_mask:0xf bank_mask:0xf
    v_rcp_f32 v14, v14
    s_nop 0
    v_mul_f32 v13, v13, v14
    s_lshl_b32 s64, s3, 6
    s_add_u32 s64, s64, 119296
    v_lshlrev_b32 v5, 2, v2
    v_add_u32 v5, s64, v5
    ds_write_b32 v5, v13
    v_lshrrev_b32 v5, 4, v0
    v_lshlrev_b32 v5, 4, v5
    v_add_u32 v5, s64, v5
    ds_read_b128 v[24:27], v5
    s_mov_b32 s57, 800000
    v_mov_b32 v48, 120064
L_lsl_41:
    ds_read_b32 v49, v48
    s_waitcnt lgkmcnt(0)
    v_readfirstlane_b32 s62, v49
    s_cmp_ge_u32 s62, 8
    s_cbranch_scc1 L_lok_40
    s_sleep 1
    s_sub_u32 s57, s57, 1
    s_cmp_lg_u32 s57, 0
    s_cbranch_scc1 L_lsl_41
L_lok_40:
    ds_read_b64_tr_b16 v[96:97], v31 offset:0
    ds_read_b64_tr_b16 v[98:99], v31 offset:4224
    ds_read_b64_tr_b16 v[112:113], v31 offset:32
    ds_read_b64_tr_b16 v[114:115], v31 offset:4256
    ds_read_b64_tr_b16 v[100:101], v31 offset:8448
    ds_read_b64_tr_b16 v[102:103], v31 offset:12672
    ds_read_b64_tr_b16 v[116:117], v31 offset:8480
    ds_read_b64_tr_b16 v[118:119], v31 offset:12704
    ds_read_b64_tr_b16 v[104:105], v31 offset:16896
    ds_read_b64_tr_b16 v[106:107], v31 offset:21120
    ds_read_b64_tr_b16 v[120:121], v31 offset:16928
    ds_read_b64_tr_b16 v[122:123], v31 offset:21152
    ds_read_b64_tr_b16 v[108:109], v31 offset:25344
    ds_read_b64_tr_b16 v[110:111], v31 offset:29568
    ds_read_b64_tr_b16 v[124:125], v31 offset:25376
    ds_read_b64_tr_b16 v[126:127], v31 offset:29600
    s_lshl_b32 s64, s3, 10
    s_lshl_b32 s65, s70, 13
    s_add_u32 s64, s64, s65
    s_add_u32 s64, s64, 1048576
    v_mov_b32 v50, 1
    v_mov_b32 v48, 120068
    s_waitcnt lgkmcnt(0)
    s_mov_b32 s57, 1600063
L_poll_42:
    s_and_b32 s53, s57, 31
    s_cselect_b32 s53, 0, 1048576
    s_add_u32 s52, s64, s53
    buffer_load_dwordx4 v[8:11], v1, s[32:35], s52 offen sc1
    s_waitcnt vmcnt(0)
L_chk_44:
    v_cmp_ne_u32 vcc, s56, v9
    v_cmp_ne_u32 s[62:63], s56, v11
    s_or_b64 vcc, vcc, s[62:63]
    s_cmp_eq_u64 vcc, 0
    s_cbranch_scc1 L_ok_43
    s_sleep 1
    s_sub_u32 s57, s57, 1
    s_cmp_lg_u32 s57, 0
    s_cbranch_scc1 L_poll_42
L_ok_43:
    ds_write2_b32 v30, v8, v10 offset0:0 offset1:1
    s_waitcnt lgkmcnt(0)
    s_barrier
    ds_read_b128 v[32:35], v3 offset:0
    ds_read_b128 v[36:39], v3 offset:64
    ds_read_b128 v[40:43], v3 offset:128
    ds_read_b128 v[44:47], v3 offset:192
    s_waitcnt lgkmcnt(3)
    v_mfma_f32_16x16x32_bf16 v[16:19], v[32:35], v[96:99], 0
    v_mfma_f32_16x16x32_bf16 v[20:23], v[32:35], v[112:115], 0
    s_waitcnt lgkmcnt(2)
    v_mfma_f32_16x16x32_bf16 v[16:19], v[36:39], v[100:103], v[16:19]
    v_mfma_f32_16x16x32_bf16 v[20:23], v[36:39], v[116:119], v[20:23]
    s_waitcnt lgkmcnt(1)
    v_mfma_f32_16x16x32_bf16 v[16:19], v[40:43], v[104:107], v[16:19]
    v_mfma_f32_16x16x32_bf16 v[20:23], v[40:43], v[120:123], v[20:23]
    s_waitcnt lgkmcnt(0)
    v_mfma_f32_16x16x32_bf16 v[16:19], v[44:47], v[108:111], v[16:19]
    v_mfma_f32_16x16x32_bf16 v[20:23], v[44:47], v[124:127], v[20:23]
    s_nop 6
    v_mul_f32 v12, v24, v16
    v_mul_f32 v13, v24, v20
    v_fmac_f32 v12, v25, v17
    v_fmac_f32 v13, v25, v21
    v_fmac_f32 v12, v26, v18
    v_fmac_f32 v13, v26, v22
    v_fmac_f32 v12, v27, v19
    v_fmac_f32 v13, v27, v23
    s_nop 1
    v_permlane16_swap_b32 v12, v13
    v_add_f32 v28, v12, v13
    v_perm_b32 v28, v29, v28, s28
    buffer_store_dword v28, v7, s[32:35], s67 offen sc1
L_bend_33:
    s_endpgm
L_t:
    s_and_b32 s61, s2, 7
    s_lshl_b32 s61, s61, 2
    s_bfe_u32 s64, s2, 0x20003
    s_add_u32 s61, s61, s64
    s_bfe_u32 s68, s2, 0x10005
    s_lshl_b32 s68, s68, 1
    s_bfe_u32 s46, s3, 0x10002
    s_add_u32 s68, s68, s46
    s_and_b32 s69, s3, 3
    v_lshlrev_b32 v1, 4, v0
    v_and_b32 v2, 15, v0
    v_lshrrev_b32 v3, 4, v0
    v_lshlrev_b32 v4, 16, v3
    v_lshl_add_u32 v4, v2, 4, v4
    v_and_b32 v5, 1, v0
    v_lshlrev_b32 v5, 10, v5
    v_lshl_add_u32 v5, v3, 4, v5
    s_lshl_b32 s60, s68, 2
    s_add_u32 s60, s60, s69
    s_lshl_b32 s54, s60, 6
    s_lshl_b32 s70, s60, 7
    s_lshl_b32 s60, s60, 18
    s_lshl_b32 s64, s61, 8
    s_add_u32 s60, s60, s64
    s_cmp_ge_u32 s3, 8
    s_cbranch_scc1 L_tuk
    s_setprio 3
    v_mov_b32 v20, 152064
    v_mov_b32 v16, 0
    v_mov_b32 v17, 0
    v_mov_b32 v18, 0
    v_mov_b32 v19, 0
    ds_write_b128 v20, v[16:19]
    ds_write_b128 v20, v[16:19] offset:16
    s_waitcnt lgkmcnt(0)
    s_load_dword s56, s[30:31], 0
    s_mov_b32 s32, s30
    s_mov_b32 s33, s31
    s_mov_b32 s34, 0x10000000
    s_mov_b32 s35, 0x20000
    s_barrier
    s_waitcnt lgkmcnt(0)
    s_mul_i32 s56, s56, 1664525
    s_add_u32 s56, s56, 1013904223
    s_mov_b32 s28, 0x03020104
    s_and_b32 s29, s56, 0xff
    s_cmp_ge_u32 s3, 2
    s_cbranch_scc1 L_tj_45
    s_lshl_b32 s64, s61, 12
    s_lshl_b32 s65, s3, 11
    s_add_u32 s64, s64, s65
    s_add_u32 s64, s64, 524288
    s_lshl_b32 s65, s3, 8
    s_add_u32 s65, s65, 151552
    v_and_b32 v6, 31, v0
    v_lshlrev_b32 v6, 3, v6
    v_lshrrev_b32 v7, 5, v0
    v_lshl_add_u32 v6, v7, 2, v6
    v_add_u32 v6, s65, v6
    s_mov_b32 s57, 1600063
L_poll_46:
    s_and_b32 s53, s57, 31
    s_cselect_b32 s53, 0, 1048576
    s_add_u32 s52, s64, s53
    buffer_load_dwordx4 v[64:67], v1, s[32:35], s52 offen offset:0 sc1
    buffer_load_dwordx4 v[68:71], v1, s[32:35], s52 offen offset:1024 sc1
    s_waitcnt vmcnt(0)
L_chk_48:
    v_xor_b32 v64, s29, v64
    v_xor_b32 v65, s29, v65
    v_or_b32 v72, v64, v65
    v_xor_b32 v66, s29, v66
    v_xor_b32 v67, s29, v67
    v_or3_b32 v72, v72, v66, v67
    v_xor_b32 v68, s29, v68
    v_xor_b32 v69, s29, v69
    v_or3_b32 v72, v72, v68, v69
    v_xor_b32 v70, s29, v70
    v_xor_b32 v71, s29, v71
    v_or3_b32 v72, v72, v70, v71
    v_and_b32 v72, 0xff, v72
    v_cmp_ne_u32 vcc, 0, v72
    s_cmp_eq_u64 vcc, 0
    s_cbranch_scc1 L_ok_47
    s_sleep 1
    s_sub_u32 s57, s57, 1
    s_cmp_lg_u32 s57, 0
    s_cbranch_scc1 L_poll_46
L_ok_47:
    v_pk_add_f32 v[64:65], v[64:65], v[68:69]
    v_pk_add_f32 v[66:67], v[66:67], v[70:71]
    s_nop 1
    v_permlane32_swap_b32 v64, v66
    v_permlane32_swap_b32 v65, v67
    v_pk_add_f32 v[64:65], v[64:65], v[66:67]
    v_cvt_pk_bf16_f32 v64, v64, v65
    ds_write_b32 v6, v64
    v_mov_b32 v16, 152080
    v_mov_b32 v17, 1
    s_mov_b64 exec, 1
    ds_add_u32 v16, v17
    s_mov_b64 exec, -1
L_tj_45:
    s_mov_b32 s57, 800000
    v_mov_b32 v16, 152072
L_lsl_51:
    ds_read_b32 v17, v16
    s_waitcnt lgkmcnt(0)
    v_readfirstlane_b32 s62, v17
    s_cmp_ge_u32 s62, 9
    s_cbranch_scc1 L_lok_50
    s_sleep 4
    s_sub_u32 s57, s57, 1
    s_cmp_lg_u32 s57, 0
    s_cbranch_scc1 L_lsl_51
L_lok_50:
    s_mov_b32 s48, s22
    s_mov_b32 s49, s23
    s_mov_b32 s50, 0x400000
    s_mov_b32 s51, 0x20000
    s_mul_i32 s47, s3, 8448
    s_setprio 0
    s_add_u32 m0, s47, 0
    s_add_u32 s64, s60, 0
    buffer_load_dwordx4 v4, s[48:51], s64 offen nt lds
    s_add_u32 m0, s47, 1056
    s_add_u32 s64, s60, 8192
    buffer_load_dwordx4 v4, s[48:51], s64 offen nt lds
    s_add_u32 m0, s47, 2112
    s_add_u32 s64, s60, 16384
    buffer_load_dwordx4 v4, s[48:51], s64 offen nt lds
    s_add_u32 m0, s47, 3168
    s_add_u32 s64, s60, 24576
    buffer_load_dwordx4 v4, s[48:51], s64 offen nt lds
    s_add_u32 m0, s47, 4224
    s_add_u32 s64, s60, 32768
    buffer_load_dwordx4 v4, s[48:51], s64 offen nt lds
    s_add_u32 m0, s47, 5280
    s_add_u32 s64, s60, 40960
    buffer_load_dwordx4 v4, s[48:51], s64 offen nt lds
    s_add_u32 m0, s47, 6336
    s_add_u32 s64, s60, 49152
    buffer_load_dwordx4 v4, s[48:51], s64 offen nt lds
    s_add_u32 m0, s47, 7392
    s_add_u32 s64, s60, 57344
    buffer_load_dwordx4 v4, s[48:51], s64 offen nt lds
    s_branch L_tw
L_tuk:
    s_setprio 2
    v_bfe_u32 v7, v0, 2, 2
    v_lshlrev_b32 v7, 16, v7
    v_lshl_add_u32 v7, v3, 6, v7
    v_and_b32 v6, 3, v0
    v_lshl_add_u32 v7, v6, 4, v7
    s_waitcnt lgkmcnt(0)
    s_load_dword s56, s[30:31], 0
    s_mov_b32 s36, s20
    s_mov_b32 s37, s21
    s_mov_b32 s38, 0x400000
    s_mov_b32 s39, 0x20000
    s_mov_b32 s32, s30
    s_mov_b32 s33, s31
    s_mov_b32 s34, 0x10000000
    s_mov_b32 s35, 0x20000
    s_add_u32 s64, s60, 0
    buffer_load_dwordx4 v[64:67], v7, s[36:39], s64 offen nt
    s_add_u32 s64, s60, 8192
    buffer_load_dwordx4 v[68:71], v7, s[36:39], s64 offen nt
    s_add_u32 s64, s60, 16384
    buffer_load_dwordx4 v[72:75], v7, s[36:39], s64 offen nt
    s_add_u32 s64, s60, 24576
    buffer_load_dwordx4 v[76:79], v7, s[36:39], s64 offen nt
    s_barrier
    s_add_u32 s64, s60, 32768
    buffer_load_dwordx4 v[80:83], v7, s[36:39], s64 offen nt
    s_add_u32 s64, s60, 40960
    buffer_load_dwordx4 v[84:87], v7, s[36:39], s64 offen nt
    s_add_u32 s64, s60, 49152
    buffer_load_dwordx4 v[88:91], v7, s[36:39], s64 offen nt
    s_add_u32 s64, s60, 57344
    buffer_load_dwordx4 v[92:95], v7, s[36:39], s64 offen nt
    s_waitcnt lgkmcnt(0)
    s_mul_i32 s56, s56, 1664525
    s_add_u32 s56, s56, 1013904223
    s_mov_b32 s28, 0x03020104
    s_and_b32 s29, s56, 0xff
    v_bfe_u32 v7, v0, 2, 1
    v_lshlrev_b32 v15, 8, v7
    v_lshl_add_u32 v15, v3, 6, v15
    v_lshl_add_u32 v15, v6, 4, v15
    v_add_u32 v15, 151552, v15
    v_lshlrev_b32 v7, 15, v7
    v_lshl_add_u32 v7, v3, 4, v7
    s_lshr_b32 s70, s70, 1
    s_lshl_b32 s64, s61, 10
    s_add_u32 s70, s70, s64
    s_add_u32 s70, s70, 131072
    s_setprio 3
    s_waitcnt vmcnt(0)
    s_mov_b32 s57, 800000
    v_mov_b32 v16, 152080
L_lw_52:
    ds_read_b32 v17, v16
    ds_read_b128 v[32:35], v15
    s_waitcnt lgkmcnt(1)
    v_readfirstlane_b32 s62, v17
    s_cmp_ge_u32 s62, 2
    s_cbranch_scc1 L_lok_53
L_lsl_54:
    ds_read_b32 v17, v16
    s_waitcnt lgkmcnt(0)
    v_readfirstlane_b32 s62, v17
    s_cmp_ge_u32 s62, 2
    s_cbranch_scc1 L_lw_52
    s_sleep 1
    s_sub_u32 s57, s57, 1
    s_cmp_lg_u32 s57, 0
    s_cbranch_scc1 L_lsl_54
L_lok_53:
    s_waitcnt lgkmcnt(0)
    v_mfma_f32_16x16x32_bf16 v[64:67], v[64:67], v[32:35], 0
    v_mfma_f32_16x16x32_bf16 v[68:71], v[68:71], v[32:35], 0
    v_mfma_f32_16x16x32_bf16 v[72:75], v[72:75], v[32:35], 0
    v_mfma_f32_16x16x32_bf16 v[76:79], v[76:79], v[32:35], 0
    v_mfma_f32_16x16x32_bf16 v[80:83], v[80:83], v[32:35], 0
    v_mfma_f32_16x16x32_bf16 v[84:87], v[84:87], v[32:35], 0
    v_mfma_f32_16x16x32_bf16 v[88:91], v[88:91], v[32:35], 0
    v_mfma_f32_16x16x32_bf16 v[92:95], v[92:95], v[32:35], 0
    s_nop 0
    v_mov_b32_dpp v44, v64 quad_perm:[0,0,0,0] row_mask:0xf bank_mask:0xf
    v_mov_b32_dpp v45, v68 quad_perm:[0,0,0,0] row_mask:0xf bank_mask:0xf
    v_mov_b32_dpp v46, v72 quad_perm:[0,0,0,0] row_mask:0xf bank_mask:0xf
    v_mov_b32_dpp v47, v76 quad_perm:[0,0,0,0] row_mask:0xf bank_mask:0xf
    v_add_f32_dpp v44, v65, v44 quad_perm:[1,1,1,1] row_mask:0xf bank_mask:0xf
    v_add_f32_dpp v45, v69, v45 quad_perm:[1,1,1,1] row_mask:0xf bank_mask:0xf
    v_add_f32_dpp v46, v73, v46 quad_perm:[1,1,1,1] row_mask:0xf bank_mask:0xf
    v_add_f32_dpp v47, v77, v47 quad_perm:[1,1,1,1] row_mask:0xf bank_mask:0xf
    v_add_f32_dpp v44, v66, v44 quad_perm:[2,2,2,2] row_mask:0xf bank_mask:0xf
    v_add_f32_dpp v45, v70, v45 quad_perm:[2,2,2,2] row_mask:0xf bank_mask:0xf
    v_add_f32_dpp v46, v74, v46 quad_perm:[2,2,2,2] row_mask:0xf bank_mask:0xf
    v_add_f32_dpp v47, v78, v47 quad_perm:[2,2,2,2] row_mask:0xf bank_mask:0xf
    v_add_f32_dpp v44, v67, v44 quad_perm:[3,3,3,3] row_mask:0xf bank_mask:0xf
    v_add_f32_dpp v45, v71, v45 quad_perm:[3,3,3,3] row_mask:0xf bank_mask:0xf
    v_add_f32_dpp v46, v75, v46 quad_perm:[3,3,3,3] row_mask:0xf bank_mask:0xf
    v_add_f32_dpp v47, v79, v47 quad_perm:[3,3,3,3] row_mask:0xf bank_mask:0xf
    v_mov_b32_dpp v48, v80 quad_perm:[0,0,0,0] row_mask:0xf bank_mask:0xf
    v_mov_b32_dpp v49, v84 quad_perm:[0,0,0,0] row_mask:0xf bank_mask:0xf
    v_mov_b32_dpp v50, v88 quad_perm:[0,0,0,0] row_mask:0xf bank_mask:0xf
    v_mov_b32_dpp v51, v92 quad_perm:[0,0,0,0] row_mask:0xf bank_mask:0xf
    v_add_f32_dpp v48, v81, v48 quad_perm:[1,1,1,1] row_mask:0xf bank_mask:0xf
    v_add_f32_dpp v49, v85, v49 quad_perm:[1,1,1,1] row_mask:0xf bank_mask:0xf
    v_add_f32_dpp v50, v89, v50 quad_perm:[1,1,1,1] row_mask:0xf bank_mask:0xf
    v_add_f32_dpp v51, v93, v51 quad_perm:[1,1,1,1] row_mask:0xf bank_mask:0xf
    v_add_f32_dpp v48, v82, v48 quad_perm:[2,2,2,2] row_mask:0xf bank_mask:0xf
    v_add_f32_dpp v49, v86, v49 quad_perm:[2,2,2,2] row_mask:0xf bank_mask:0xf
    v_add_f32_dpp v50, v90, v50 quad_perm:[2,2,2,2] row_mask:0xf bank_mask:0xf
    v_add_f32_dpp v51, v94, v51 quad_perm:[2,2,2,2] row_mask:0xf bank_mask:0xf
    v_add_f32_dpp v48, v83, v48 quad_perm:[3,3,3,3] row_mask:0xf bank_mask:0xf
    v_add_f32_dpp v49, v87, v49 quad_perm:[3,3,3,3] row_mask:0xf bank_mask:0xf
    v_add_f32_dpp v50, v91, v50 quad_perm:[3,3,3,3] row_mask:0xf bank_mask:0xf
    v_add_f32_dpp v51, v95, v51 quad_perm:[3,3,3,3] row_mask:0xf bank_mask:0xf
    v_cvt_pk_bf16_f32 v36, v44, v45
    v_cvt_pk_bf16_f32 v37, v46, v47
    v_cvt_pk_bf16_f32 v38, v48, v49
    v_cvt_pk_bf16_f32 v39, v50, v51
    s_mov_b32 exec_lo, 0x00110011
    s_mov_b32 exec_hi, 0x00110011
    buffer_store_dwordx4 v[36:39], v7, s[32:35], s70 offen sc1
    s_mov_b64 exec, -1
    s_lshl_b32 s60, s61, 17
    s_lshl_b32 s64, s69, 15
    s_add_u32 s60, s60, s64
    s_lshl_b32 s64, s68, 8
    s_add_u32 s60, s60, s64
    v_lshlrev_b32 v4, 13, v3
    v_lshl_add_u32 v4, v2, 4, v4
    s_mov_b32 s48, s24
    s_mov_b32 s49, s25
    s_mov_b32 s50, 0x400000
    s_mov_b32 s51, 0x20000
    s_mul_i32 s47, s3, 8448
    s_waitcnt vmcnt(0)
    v_mov_b32 v16, 152072
    v_mov_b32 v17, 1
    s_mov_b64 exec, 1
    ds_add_u32 v16, v17
    s_mov_b64 exec, -1
    s_cmp_lg_u32 s3, 8
    s_cbranch_scc1 L_nfl_55
    s_mov_b32 s57, 800000
    v_mov_b32 v16, 152072
L_lsl_58:
    ds_read_b32 v17, v16
    s_waitcnt lgkmcnt(0)
    v_readfirstlane_b32 s62, v17
    s_cmp_ge_u32 s62, 8
    s_cbranch_scc1 L_lok_57
    s_sleep 1
    s_sub_u32 s57, s57, 1
    s_cmp_lg_u32 s57, 0
    s_cbranch_scc1 L_lsl_58
L_lok_57:
    v_mov_b32 v18, s56
    v_mov_b32 v19, 0
    s_lshl_b32 s64, s2, 7
    s_add_u32 s64, s64, 4096
    s_mov_b64 exec, 1
    buffer_store_dword v18, v19, s[32:35], s64 offen sc1
    s_mov_b64 exec, -1
    v_mov_b32 v16, 152072
    v_mov_b32 v17, 1
    s_mov_b64 exec, 1
    ds_add_u32 v16, v17
    s_mov_b64 exec, -1
L_nfl_55:
    s_setprio 0
    s_mov_b32 s57, 800000
    v_mov_b32 v16, 152072
L_lsl_61:
    ds_read_b32 v17, v16
    s_waitcnt lgkmcnt(0)
    v_readfirstlane_b32 s62, v17
    s_cmp_ge_u32 s62, 9
    s_cbranch_scc1 L_lok_60
    s_sleep 4
    s_sub_u32 s57, s57, 1
    s_cmp_lg_u32 s57, 0
    s_cbranch_scc1 L_lsl_61
L_lok_60:
    s_add_u32 m0, s47, 0
    s_add_u32 s64, s60, 0
    buffer_load_dwordx4 v4, s[48:51], s64 offen nt lds
    s_add_u32 m0, s47, 1056
    s_add_u32 s64, s60, 1024
    buffer_load_dwordx4 v4, s[48:51], s64 offen nt lds
    s_add_u32 m0, s47, 2112
    s_add_u32 s64, s60, 2048
    buffer_load_dwordx4 v4, s[48:51], s64 offen nt lds
    s_add_u32 m0, s47, 3168
    s_add_u32 s64, s60, 3072
    buffer_load_dwordx4 v4, s[48:51], s64 offen nt lds
    s_add_u32 m0, s47, 4224
    s_add_u32 s64, s60, 4096
    buffer_load_dwordx4 v4, s[48:51], s64 offen nt lds
    s_add_u32 m0, s47, 5280
    s_add_u32 s64, s60, 5120
    buffer_load_dwordx4 v4, s[48:51], s64 offen nt lds
    s_add_u32 m0, s47, 6336
    s_add_u32 s64, s60, 6144
    buffer_load_dwordx4 v4, s[48:51], s64 offen nt lds
    s_add_u32 m0, s47, 7392
    s_add_u32 s64, s60, 7168
    buffer_load_dwordx4 v4, s[48:51], s64 offen nt lds
L_tw:
    s_lshr_b32 s66, s3, 2
    s_mul_i32 s66, s66, 33792
    v_bfe_u32 v31, v0, 2, 2
    v_mul_u32_u24 v31, 1056, v31
    v_lshl_add_u32 v31, v3, 8, v31
    v_and_b32 v10, 3, v0
    v_lshl_add_u32 v31, v10, 3, v31
    s_lshl_b32 s64, s69, 6
    s_add_u32 s64, s64, s66
    v_add_u32 v31, s64, v31
    s_waitcnt vmcnt(0) lgkmcnt(0)
    s_barrier
    ds_read_b64_tr_b16 v[96:97], v31 offset:0
    ds_read_b64_tr_b16 v[98:99], v31 offset:4224
    ds_read_b64_tr_b16 v[112:113], v31 offset:32
    ds_read_b64_tr_b16 v[114:115], v31 offset:4256
    ds_read_b64_tr_b16 v[100:101], v31 offset:8448
    ds_read_b64_tr_b16 v[102:103], v31 offset:12672
    ds_read_b64_tr_b16 v[116:117], v31 offset:8480
    ds_read_b64_tr_b16 v[118:119], v31 offset:12704
    ds_read_b64_tr_b16 v[104:105], v31 offset:16896
    ds_read_b64_tr_b16 v[106:107], v31 offset:21120
    ds_read_b64_tr_b16 v[120:121], v31 offset:16928
    ds_read_b64_tr_b16 v[122:123], v31 offset:21152
    ds_read_b64_tr_b16 v[108:109], v31 offset:25344
    ds_read_b64_tr_b16 v[110:111], v31 offset:29568
    ds_read_b64_tr_b16 v[124:125], v31 offset:25376
    ds_read_b64_tr_b16 v[126:127], v31 offset:29600
    s_lshl_b32 s60, s61, 12
    s_lshl_b32 s65, s69, 10
    s_add_u32 s65, s65, s60
    s_add_u32 s65, s65, 655360
    buffer_load_dwordx4 v[32:35], v1, s[32:35], s65 offen sc1
    s_lshl_b32 s64, s61, 4
    s_add_u32 s64, s64, 327680
    s_lshl_b32 s65, s61, 1
    s_bfe_u32 s66, s2, 0x10005
    s_add_u32 s65, s65, s66
    s_mul_i32 s65, s65, 32768
    s_lshl_b32 s66, s3, 11
    s_add_u32 s65, s65, s66
    s_add_u32 s65, s65, 4194304
    s_and_b32 s66, s3, 7
    s_lshl_b32 s66, s66, 5
    s_add_u32 s66, s66, 152576
    v_lshlrev_b32 v4, 2, v3
    v_add_u32 v4, s66, v4
    s_lshl_b32 s66, s46, 3
    s_add_u32 s66, s66, s69
    s_mul_i32 s66, s66, 272
    s_lshr_b32 s67, s3, 3
    s_mul_i32 s67, s67, 4608
    s_add_u32 s66, s66, s67
    s_add_u32 s66, s66, 67584
    v_lshlrev_b32 v5, 4, v2
    v_lshl_add_u32 v5, v3, 2, v5
    v_add_u32 v5, s66, v5
    v_mul_u32_u24 v6, 272, v2
    v_lshl_add_u32 v3, v3, 4, v6
    v_add_u32 v3, 67584, v3
    v_mov_b32 v29, s56
    v_lshrrev_b32 v7, 5, v0
    v_lshlrev_b32 v6, 11, v7
    v_and_b32 v8, 31, v0
    v_lshl_add_u32 v6, v8, 2, v6
    v_lshlrev_b32 v7, 16, v7
    v_lshl_add_u32 v7, v8, 2, v7
    s_lshl_b32 s67, s68, 2
    s_add_u32 s67, s67, s69
    s_lshl_b32 s67, s67, 5
    s_add_u32 s67, s67, s61
    s_lshl_b32 s67, s67, 7
    s_cmp_lg_u32 s3, 15
    s_cbranch_scc1 L_nopoll_62
    v_lshlrev_b32 v12, 9, v0
    s_mov_b32 s57, 200000
L_poll_64:
    buffer_load_dwordx4 v[8:11], v12, s[32:35], s64 offen sc1
    s_waitcnt vmcnt(0)
L_chk_66:
    v_cmp_ne_u32 vcc, s56, v9
    v_cmp_ne_u32 s[62:63], s56, v11
    s_or_b64 vcc, vcc, s[62:63]
    s_cmp_eq_u64 vcc, 0
    s_cbranch_scc1 L_ok_65
    s_sleep 2
    s_sub_u32 s57, s57, 1
    s_cmp_lg_u32 s57, 0
    s_cbranch_scc1 L_poll_64
L_ok_65:
L_nopoll_62:
    s_waitcnt lgkmcnt(0)
    s_barrier
    buffer_load_dwordx4 v[32:35], v1, s[32:35], s65 offen offset:0 sc1
    buffer_load_dwordx4 v[36:39], v1, s[32:35], s65 offen offset:1024 sc1
    s_cmp_lg_u32 s3, 15
    s_cbranch_scc1 L_nopoll_63
    v_max_f32_dpp v12, v8, v8 quad_perm:[1,0,3,2] row_mask:0xf bank_mask:0xf
    s_nop 1
    v_max_f32_dpp v12, v12, v12 quad_perm:[2,3,0,1] row_mask:0xf bank_mask:0xf
    s_nop 1
    v_max_f32_dpp v12, v12, v12 row_half_mirror row_mask:0xf bank_mask:0xf
    s_nop 1
    v_max_f32_dpp v12, v12, v12 row_mirror row_mask:0xf bank_mask:0xf
    v_mov_b32 v15, v12
    s_nop 1
    v_permlane16_swap_b32 v12, v15
    v_max_f32 v12, v12, v15
    v_sub_f32 v13, v8, v12
    v_exp_f32 v13, v13
    s_nop 0
    v_mul_f32 v14, v13, v10
    s_nop 1
    v_add_f32_dpp v14, v14, v14 quad_perm:[1,0,3,2] row_mask:0xf bank_mask:0xf
    s_nop 1
    v_add_f32_dpp v14, v14, v14 quad_perm:[2,3,0,1] row_mask:0xf bank_mask:0xf
    s_nop 1
    v_add_f32_dpp v14, v14, v14 row_half_mirror row_mask:0xf bank_mask:0xf
    s_nop 1
    v_add_f32_dpp v14, v14, v14 row_mirror row_mask:0xf bank_mask:0xf
    v_mov_b32 v15, v14
    s_nop 1
    v_permlane16_swap_b32 v14, v15
    v_add_f32 v14, v14, v15
    v_rcp_f32 v14, v14
    v_lshlrev_b32 v12, 2, v0
    v_add_u32 v12, 152576, v12
    v_mul_f32 v13, v13, v14
    ds_write_b32 v12, v13
    s_waitcnt lgkmcnt(0)
L_nopoll_63:
    s_barrier
    ds_read2_b32 v[8:9], v4 offset0:0 offset1:4
    s_waitcnt lgkmcnt(0)
    s_waitcnt vmcnt(1)
    v_lshlrev_b32 v24, 16, v32
    v_and_b32 v25, 0xffff0000, v32
    v_mul_f32 v16, v8, v24
    v_mul_f32 v17, v8, v25
    v_lshlrev_b32 v24, 16, v33
    v_and_b32 v25, 0xffff0000, v33
    v_mul_f32 v18, v8, v24
    v_mul_f32 v19, v8, v25
    v_lshlrev_b32 v24, 16, v34
    v_and_b32 v25, 0xffff0000, v34
    v_mul_f32 v20, v8, v24
    v_mul_f32 v21, v8, v25
    v_lshlrev_b32 v24, 16, v35
    v_and_b32 v25, 0xffff0000, v35
    v_mul_f32 v22, v8, v24
    v_mul_f32 v23, v8, v25
    s_waitcnt vmcnt(0)
    v_lshlrev_b32 v24, 16, v36
    v_and_b32 v25, 0xffff0000, v36
    v_fmac_f32 v16, v9, v24
    v_fmac_f32 v17, v9, v25
    v_lshlrev_b32 v24, 16, v37
    v_and_b32 v25, 0xffff0000, v37
    v_fmac_f32 v18, v9, v24
    v_fmac_f32 v19, v9, v25
    v_lshlrev_b32 v24, 16, v38
    v_and_b32 v25, 0xffff0000, v38
    v_fmac_f32 v20, v9, v24
    v_fmac_f32 v21, v9, v25
    v_lshlrev_b32 v24, 16, v39
    v_and_b32 v25, 0xffff0000, v39
    v_fmac_f32 v22, v9, v24
    v_fmac_f32 v23, v9, v25
    v_permlane32_swap_b32 v16, v20
    v_permlane32_swap_b32 v17, v21
    v_permlane32_swap_b32 v18, v22
    v_permlane32_swap_b32 v19, v23
    v_add_f32 v16, v16, v20
    v_add_f32 v17, v17, v21
    v_add_f32 v18, v18, v22
    v_add_f32 v19, v19, v23
    s_nop 0
    v_permlane16_swap_b32 v16, v18
    v_permlane16_swap_b32 v17, v19
    v_add_f32 v16, v16, v18
    v_add_f32 v17, v17, v19
    v_cvt_pk_bf16_f32 v16, v16, v17
    ds_write_b32 v5, v16
    s_waitcnt lgkmcnt(0)
    s_barrier
    s_cmp_ge_u32 s3, 8
    s_cbranch_scc1 L_to
    s_mul_i32 s64, s46, 4608
    v_add_u32 v3, s64, v3
    s_mov_b32 s47, s64
    s_lshl_b32 s64, s68, 9
    s_add_u32 s64, s64, s60
    s_lshl_b32 s65, s69, 7
    s_add_u32 s64, s64, s65
    s_add_u32 s64, s64, 655360
    ds_read_b128 v[32:35], v3 offset:0
    ds_read_b128 v[36:39], v3 offset:64
    ds_read_b128 v[40:43], v3 offset:128
    ds_read_b128 v[44:47], v3 offset:192
    s_waitcnt lgkmcnt(3)
    v_mfma_f32_16x16x32_bf16 v[16:19], v[32:35], v[96:99], 0
    v_mfma_f32_16x16x32_bf16 v[20:23], v[32:35], v[112:115], 0
    s_waitcnt lgkmcnt(2)
    v_mfma_f32_16x16x32_bf16 v[16:19], v[36:39], v[100:103], v[16:19]
    v_mfma_f32_16x16x32_bf16 v[20:23], v[36:39], v[116:119], v[20:23]
    s_waitcnt lgkmcnt(1)
    v_mfma_f32_16x16x32_bf16 v[16:19], v[40:43], v[104:107], v[16:19]
    v_mfma_f32_16x16x32_bf16 v[20:23], v[40:43], v[120:123], v[20:23]
    s_waitcnt lgkmcnt(0)
    v_mfma_f32_16x16x32_bf16 v[16:19], v[44:47], v[108:111], v[16:19]
    v_mfma_f32_16x16x32_bf16 v[20:23], v[44:47], v[124:127], v[20:23]
    s_nop 6
    v_pk_add_f32 v[16:17], v[16:17], v[18:19]
    v_pk_add_f32 v[20:21], v[20:21], v[22:23]
    v_add_f32 v12, v16, v17
    v_add_f32 v13, v20, v21
    s_nop 1
    v_permlane16_swap_b32 v12, v13
    v_mov_b32 v28, v12
    v_perm_b32 v28, v29, v28, s28
    buffer_store_dword v28, v6, s[32:35], s64 offen
    s_add_u32 s53, s64, 1048576
    buffer_store_dword v28, v6, s[32:35], s53 offen sc1
    s_cmp_lg_u32 s3, 0
    s_cbranch_scc1 L_tend_67
    s_cmp_lt_u32 s2, 32
    s_cbranch_scc1 L_fa_68
    s_sub_u32 s60, s2, 32
    s_mov_b32 s36, s26
    s_mov_b32 s37, s27
    s_mov_b32 s38, 0x1000
    s_mov_b32 s39, 0x20000
    s_lshl_b32 s64, s60, 12
    s_add_u32 s64, s64, 917504
    s_lshr_b32 s66, s60, 4
    s_lshl_b32 s66, s66, 11
    s_and_b32 s65, s60, 15
    s_lshl_b32 s65, s65, 6
    s_add_u32 s66, s66, s65
    s_add_u32 s66, s66, 1024
    v_and_b32 v2, 7, v0
    v_lshlrev_b32 v2, 3, v2
    v_lshrrev_b32 v4, 4, v0
    v_lshl_add_u32 v2, v4, 1, v2
    v_and_b32 v5, 7, v0
    v_lshlrev_b32 v5, 4, v5
    s_mov_b32 s57, 200000
L_poll_69:
    buffer_load_dwordx2 v[32:33], v5, s[32:35], s64 offen sc1
    s_waitcnt vmcnt(0)
L_chk_71:
    v_xor_b32 v32, s29, v32
    v_xor_b32 v33, s29, v33
    v_or_b32 v48, v32, v33
    v_and_b32 v48, 0xff, v48
    v_cmp_ne_u32 vcc, 0, v48
    s_cmp_eq_u64 vcc, 0
    s_cbranch_scc1 L_ok_70
    s_sleep 2
    s_sub_u32 s57, s57, 1
    s_cmp_lg_u32 s57, 0
    s_cbranch_scc1 L_poll_69
L_ok_70:
    s_mov_b32 s57, 200000
L_poll_72:
    buffer_load_dwordx4 v[32:35], v1, s[32:35], s64 offen offset:0 sc1
    buffer_load_dwordx4 v[36:39], v1, s[32:35], s64 offen offset:1024 sc1
    buffer_load_dwordx4 v[40:43], v1, s[32:35], s64 offen offset:2048 sc1
    buffer_load_dwordx4 v[44:47], v1, s[32:35], s64 offen offset:3072 sc1
    s_waitcnt vmcnt(0)
L_chk_74:
    v_xor_b32 v32, s29, v32
    v_xor_b32 v33, s29, v33
    v_or_b32 v48, v32, v33
    v_xor_b32 v34, s29, v34
    v_xor_b32 v35, s29, v35
    v_or3_b32 v48, v48, v34, v35
    v_xor_b32 v36, s29, v36
    v_xor_b32 v37, s29, v37
    v_or3_b32 v48, v48, v36, v37
    v_xor_b32 v38, s29, v38
    v_xor_b32 v39, s29, v39
    v_or3_b32 v48, v48, v38, v39
    v_xor_b32 v40, s29, v40
    v_xor_b32 v41, s29, v41
    v_or3_b32 v48, v48, v40, v41
    v_xor_b32 v42, s29, v42
    v_xor_b32 v43, s29, v43
    v_or3_b32 v48, v48, v42, v43
    v_xor_b32 v44, s29, v44
    v_xor_b32 v45, s29, v45
    v_or3_b32 v48, v48, v44, v45
    v_xor_b32 v46, s29, v46
    v_xor_b32 v47, s29, v47
    v_or3_b32 v48, v48, v46, v47
    v_and_b32 v48, 0xff, v48
    v_cmp_ne_u32 vcc, 0, v48
    s_cmp_eq_u64 vcc, 0
    s_cbranch_scc1 L_ok_73
    s_sleep 1
    s_sub_u32 s57, s57, 1
    s_cmp_lg_u32 s57, 0
    s_cbranch_scc1 L_poll_72
L_ok_73:
    v_pk_add_f32 v[32:33], v[32:33], v[40:41]
    v_pk_add_f32 v[34:35], v[34:35], v[42:43]
    v_pk_add_f32 v[36:37], v[36:37], v[44:45]
    v_pk_add_f32 v[38:39], v[38:39], v[46:47]
    v_pk_add_f32 v[32:33], v[32:33], v[36:37]
    v_pk_add_f32 v[34:35], v[34:35], v[38:39]
    s_nop 1
    v_permlane32_swap_b32 v32, v34
    v_permlane32_swap_b32 v33, v35
    v_pk_add_f32 v[32:33], v[32:33], v[34:35]
    s_nop 1
    v_permlane16_swap_b32 v32, v33
    v_add_f32 v32, v32, v33
    s_nop 1
    v_add_f32_dpp v32, v32, v32 row_ror:8 row_mask:0xf bank_mask:0xf
    v_cvt_pk_bf16_f32 v32, v32, v32
    s_mov_b32 exec_lo, 0x00ff00ff
    s_mov_b32 exec_hi, 0x00ff00ff
    buffer_store_short v32, v2, s[36:39], s66 offen
    s_mov_b64 exec, -1
    s_cmp_lg_u32 s2, 32
    s_cbranch_scc1 L_tend_67
    s_mov_b64 exec, 1
    v_mov_b32 v3, s56
    v_mov_b32 v4, 0
    buffer_store_dword v3, v4, s[32:35], 0 offen offset:0 sc1
    s_mov_b64 exec, -1
    s_branch L_tend_67
L_fa_68:
    s_mov_b32 s36, s26
    s_mov_b32 s37, s27
    s_mov_b32 s38, 0x1000
    s_mov_b32 s39, 0x20000
    s_lshl_b32 s64, s2, 12
    s_add_u32 s64, s64, 786432
    s_lshr_b32 s66, s2, 4
    s_lshl_b32 s66, s66, 11
    s_and_b32 s65, s2, 15
    s_lshl_b32 s65, s65, 6
    s_add_u32 s66, s66, s65
    s_add_u32 s66, s66, 0
    v_and_b32 v2, 7, v0
    v_lshlrev_b32 v2, 3, v2
    v_lshrrev_b32 v4, 4, v0
    v_lshl_add_u32 v2, v4, 1, v2
    v_and_b32 v5, 7, v0
    v_lshlrev_b32 v5, 4, v5
    s_mov_b32 s57, 200000
L_poll_75:
    buffer_load_dwordx2 v[32:33], v5, s[32:35], s64 offen sc1
    s_waitcnt vmcnt(0)
L_chk_77:
    v_xor_b32 v32, s29, v32
    v_xor_b32 v33, s29, v33
    v_or_b32 v48, v32, v33
    v_and_b32 v48, 0xff, v48
    v_cmp_ne_u32 vcc, 0, v48
    s_cmp_eq_u64 vcc, 0
    s_cbranch_scc1 L_ok_76
    s_sleep 2
    s_sub_u32 s57, s57, 1
    s_cmp_lg_u32 s57, 0
    s_cbranch_scc1 L_poll_75
L_ok_76:
    s_mov_b32 s57, 200000
L_poll_78:
    buffer_load_dwordx4 v[32:35], v1, s[32:35], s64 offen offset:0 sc1
    buffer_load_dwordx4 v[36:39], v1, s[32:35], s64 offen offset:1024 sc1
    buffer_load_dwordx4 v[40:43], v1, s[32:35], s64 offen offset:2048 sc1
    buffer_load_dwordx4 v[44:47], v1, s[32:35], s64 offen offset:3072 sc1
    s_waitcnt vmcnt(0)
L_chk_80:
    v_xor_b32 v32, s29, v32
    v_xor_b32 v33, s29, v33
    v_or_b32 v48, v32, v33
    v_xor_b32 v34, s29, v34
    v_xor_b32 v35, s29, v35
    v_or3_b32 v48, v48, v34, v35
    v_xor_b32 v36, s29, v36
    v_xor_b32 v37, s29, v37
    v_or3_b32 v48, v48, v36, v37
    v_xor_b32 v38, s29, v38
    v_xor_b32 v39, s29, v39
    v_or3_b32 v48, v48, v38, v39
    v_xor_b32 v40, s29, v40
    v_xor_b32 v41, s29, v41
    v_or3_b32 v48, v48, v40, v41
    v_xor_b32 v42, s29, v42
    v_xor_b32 v43, s29, v43
    v_or3_b32 v48, v48, v42, v43
    v_xor_b32 v44, s29, v44
    v_xor_b32 v45, s29, v45
    v_or3_b32 v48, v48, v44, v45
    v_xor_b32 v46, s29, v46
    v_xor_b32 v47, s29, v47
    v_or3_b32 v48, v48, v46, v47
    v_and_b32 v48, 0xff, v48
    v_cmp_ne_u32 vcc, 0, v48
    s_cmp_eq_u64 vcc, 0
    s_cbranch_scc1 L_ok_79
    s_sleep 1
    s_sub_u32 s57, s57, 1
    s_cmp_lg_u32 s57, 0
    s_cbranch_scc1 L_poll_78
L_ok_79:
    v_pk_add_f32 v[32:33], v[32:33], v[40:41]
    v_pk_add_f32 v[34:35], v[34:35], v[42:43]
    v_pk_add_f32 v[36:37], v[36:37], v[44:45]
    v_pk_add_f32 v[38:39], v[38:39], v[46:47]
    v_pk_add_f32 v[32:33], v[32:33], v[36:37]
    v_pk_add_f32 v[34:35], v[34:35], v[38:39]
    s_nop 1
    v_permlane32_swap_b32 v32, v34
    v_permlane32_swap_b32 v33, v35
    v_pk_add_f32 v[32:33], v[32:33], v[34:35]
    s_nop 1
    v_permlane16_swap_b32 v32, v33
    v_add_f32 v32, v32, v33
    s_nop 1
    v_add_f32_dpp v32, v32, v32 row_ror:8 row_mask:0xf bank_mask:0xf
    v_cvt_pk_bf16_f32 v32, v32, v32
    s_mov_b32 exec_lo, 0x00ff00ff
    s_mov_b32 exec_hi, 0x00ff00ff
    buffer_store_short v32, v2, s[36:39], s66 offen
    s_mov_b64 exec, -1
    s_branch L_tend_67
L_to:
    s_cmp_ge_u32 s3, 12
    s_cbranch_scc1 L_nctx_81
    s_lshl_b32 s64, s69, 10
    s_add_u32 s64, s64, s60
    s_add_u32 s64, s64, 655360
    s_lshr_b32 s65, s69, 1
    s_lshl_b32 s65, s65, 2
    s_and_b32 s66, s69, 1
    s_add_u32 s65, s65, s66
    s_mul_i32 s65, s65, 544
    s_add_u32 s65, s65, 76800
    v_lshrrev_b32 v5, 5, v0
    v_mul_u32_u24 v5, 272, v5
    v_and_b32 v4, 31, v0
    v_lshl_add_u32 v5, v4, 3, v5
    v_add_u32 v5, s65, v5
    s_mov_b32 s57, 1600063
L_poll_82:
    s_and_b32 s53, s57, 31
    s_cselect_b32 s53, 0, 1048576
    s_add_u32 s52, s64, s53
    buffer_load_dwordx4 v[8:11], v1, s[32:35], s52 offen sc1
    s_waitcnt vmcnt(0)
L_chk_84:
    v_xor_b32 v8, s29, v8
    v_xor_b32 v9, s29, v9
    v_or_b32 v12, v8, v9
    v_xor_b32 v10, s29, v10
    v_xor_b32 v11, s29, v11
    v_or3_b32 v12, v12, v10, v11
    v_and_b32 v12, 0xff, v12
    v_cmp_ne_u32 vcc, 0, v12
    s_cmp_eq_u64 vcc, 0
    s_cbranch_scc1 L_ok_83
    s_sleep 1
    s_sub_u32 s57, s57, 1
    s_cmp_lg_u32 s57, 0
    s_cbranch_scc1 L_poll_82
L_ok_83:
    v_cvt_pk_bf16_f32 v8, v8, v9
    v_cvt_pk_bf16_f32 v9, v10, v11
    ds_write_b64 v5, v[8:9]
    v_mov_b32 v48, 152084
    v_mov_b32 v49, 1
    s_mov_b64 exec, 1
    ds_add_u32 v48, v49
    s_mov_b64 exec, -1
L_nctx_81:
    s_mov_b32 s57, 800000
    v_mov_b32 v48, 152084
L_lw_85:
    ds_read_b32 v49, v48
    ds_read_b128 v[32:35], v3 offset:9216
    ds_read_b128 v[36:39], v3 offset:9280
    ds_read_b128 v[40:43], v3 offset:9344
    ds_read_b128 v[44:47], v3 offset:9408
    s_waitcnt lgkmcnt(4)
    v_readfirstlane_b32 s62, v49
    s_cmp_ge_u32 s62, 4
    s_cbranch_scc1 L_lok_86
L_lsl_87:
    ds_read_b32 v49, v48
    s_waitcnt lgkmcnt(0)
    v_readfirstlane_b32 s62, v49
    s_cmp_ge_u32 s62, 4
    s_cbranch_scc1 L_lw_85
    s_sleep 1
    s_sub_u32 s57, s57, 1
    s_cmp_lg_u32 s57, 0
    s_cbranch_scc1 L_lsl_87
L_lok_86:
    s_waitcnt lgkmcnt(3)
    v_mfma_f32_16x16x32_bf16 v[16:19], v[32:35], v[96:99], 0
    v_mfma_f32_16x16x32_bf16 v[20:23], v[32:35], v[112:115], 0
    s_waitcnt lgkmcnt(2)
    v_mfma_f32_16x16x32_bf16 v[16:19], v[36:39], v[100:103], v[16:19]
    v_mfma_f32_16x16x32_bf16 v[20:23], v[36:39], v[116:119], v[20:23]
    s_waitcnt lgkmcnt(1)
    v_mfma_f32_16x16x32_bf16 v[16:19], v[40:43], v[104:107], v[16:19]
    v_mfma_f32_16x16x32_bf16 v[20:23], v[40:43], v[120:123], v[20:23]
    s_waitcnt lgkmcnt(0)
    v_mfma_f32_16x16x32_bf16 v[16:19], v[44:47], v[108:111], v[16:19]
    v_mfma_f32_16x16x32_bf16 v[20:23], v[44:47], v[124:127], v[20:23]
    s_nop 6
    v_pk_add_f32 v[16:17], v[16:17], v[18:19]
    v_pk_add_f32 v[20:21], v[20:21], v[22:23]
    v_add_f32 v12, v16, v17
    v_add_f32 v13, v20, v21
    s_nop 1
    v_permlane16_swap_b32 v12, v13
    v_mov_b32 v28, v12
    v_perm_b32 v28, v29, v28, s28
    s_add_u32 s64, s67, 917504
    buffer_store_dword v28, v7, s[32:35], s64 offen sc1
L_tend_67:
    s_endpgm
.section .rodata,"a"
.p2align 6
.amdhsa_kernel concat_heads__gqa_block_cached__compressed_kv_cla__decode_kernel
  .amdhsa_next_free_vgpr 128
  .amdhsa_next_free_sgpr 100
  .amdhsa_accum_offset 128
  .amdhsa_group_segment_fixed_size 0
  .amdhsa_kernarg_size 112
  .amdhsa_user_sgpr_count 2
  .amdhsa_user_sgpr_kernarg_segment_ptr 1
  .amdhsa_system_sgpr_workgroup_id_x 1
.end_amdhsa_kernel
```
